```python
import torch

def _softmax(x, axis=-1):
    return torch.softmax(x, dim=axis)

def _gelu(x):
    return torch.nn.functional.gelu(x, approximate='tanh')

def _silu(x):
    return torch.nn.functional.silu(x)

def _sigmoid(x):
    return torch.sigmoid(x)

def _layernorm(x, axis=-1, eps=1e-05):
    m = x.mean(dim=axis, keepdim=True)
    v = x.var(dim=axis, keepdim=True, unbiased=False)
    return (x - m) / torch.sqrt(v + eps)

def _scatter_add(tgt, idx, src, axis=0):
    return tgt.clone().index_add_(axis, idx, src)

def _segment_sum(src, seg, n):
    out = torch.zeros((n,) + src.shape[1:], dtype=src.dtype)
    return out.index_add_(0, seg, src)

def _pad(x, pw):
    flat = tuple((v for pair in reversed(pw) for v in pair))
    return torch.nn.functional.pad(x, flat)
kernel_name = 'standalone__video_timesformer__vision'

def setup_inputs():

    _w = lambda a: (lambda t: t.to(torch.bfloat16) if t.is_floating_point() else t)(torch.as_tensor(a))
    T = 8
    p = 14
    HW = 512 // p * p
    N = (HW // p) ** 2
    C = 192
    return {'x': _w((lambda *s: torch.randn(*s, dtype=torch.bfloat16) * 0.1)(1, T, N, C)), 'wqkv_t': _w((lambda *s: torch.randn(*s, dtype=torch.bfloat16) * 0.1)(C, 3 * C)), 'wo_t': _w((lambda *s: torch.randn(*s, dtype=torch.bfloat16) * 0.1)(C, C)), 'wqkv_s': _w((lambda *s: torch.randn(*s, dtype=torch.bfloat16) * 0.1)(C, 3 * C)), 'wo_s': _w((lambda *s: torch.randn(*s, dtype=torch.bfloat16) * 0.8)(C, C))}

def reference(x, wqkv_t, wo_t, wqkv_s, wo_s):
    B, T, N, C = x.shape
    scale = C ** (-0.5)
    xt = (lambda x, *d: x.permute(*d))(x, 0, 2, 1, 3).reshape(B * N, T, C)
    h = _layernorm(xt, axis=-1)
    qkv = h @ wqkv_t
    q, k, v = (qkv[..., :C].clone(), qkv[..., C:2 * C].clone(), qkv[..., 2 * C:].clone())
    a = _softmax(torch.einsum('btc,bsc->bts', q, k) * scale, axis=-1)
    xt = xt + torch.einsum('bts,bsc->btc', a, v) @ wo_t
    x1 = (lambda x, *d: x.permute(*d))(xt.reshape(B, N, T, C), 0, 2, 1, 3)
    xs = x1.reshape(B * T, N, C)
    h = _layernorm(xs, axis=-1)
    qkv = h @ wqkv_s
    q, k, v = (qkv[..., :C].clone(), qkv[..., C:2 * C].clone(), qkv[..., 2 * C:].clone())
    a = _softmax(torch.einsum('bnc,bmc->bnm', q, k) * scale, axis=-1)
    xs = xs + torch.einsum('bnm,bmc->bnc', a, v) @ wo_s
    return xs.reshape(B, T, N, C)
```

```asm
; @launch kernel=k1_kernel grid=(256,1,1) block=(256,1,1) lds=161280
; @launch kernel=k2_kernel grid=(216,1,1) block=(256,1,1) lds=163840
.amdgcn_target "amdgcn-amd-amdhsa--gfx950"
.text
.globl k1_kernel
.p2align 8
.type k1_kernel,@function
k1_kernel:
    s_cmp_ge_u32 s2, 256
    s_cbranch_scc1 K1_EXIT
    s_cmp_ge_u32 s2, 216
    s_cbranch_scc1 K1_SIDE
    s_load_dwordx2 s[4:5], s[0:1], 0
    s_load_dwordx2 s[8:9], s[0:1], 8
    s_load_dwordx2 s[12:13], s[0:1], 16
    s_load_dwordx2 s[16:17], s[0:1], 56
    v_lshrrev_b32 v230, 6, v0
    v_and_b32 v250, 63, v0
    v_readfirstlane_b32 s20, v230
    v_and_b32 v251, 15, v250
    v_lshrrev_b32 v252, 4, v250
    v_lshlrev_b32 v249, 4, v250
    s_getpc_b64 s[88:89]
K1_PC:
    s_sub_u32 s88, s88, K1_PC-k1_kernel
    s_subb_u32 s89, s89, 0
    s_and_b32 s89, s89, 0xffff
    s_mov_b32 s90, K1_CODE_END-k1_kernel
    s_mov_b32 s91, 0x20000
    s_lshr_b32 s38, s2, 3
    s_lshl_b32 s38, s38, 2
    s_add_u32 s38, s38, s20
    s_lshl_b32 s38, s38, 1
    v_and_b32 v231, 1, v250
    v_add_u32 v231, s38, v231
    v_lshlrev_b32 v231, 7, v231
    buffer_load_dword a251, v231, s[88:91], 0 offen
    s_mul_i32 s22, s2, 6
    s_min_u32 s23, s20, 2
    s_mul_i32 s21, s20, 27648
    v_and_b32 v230, 7, v251
    s_mov_b32 s24, 497664
    v_mul_lo_u32 v230, v230, s24
    v_lshrrev_b32 v231, 3, v251
    v_mul_u32_u24 v231, 384, v231
    v_lshl_add_u32 v231, v252, 4, v231
    v_add_u32_e64 v234, v230, v231
    s_lshl_b32 s37, s23, 1
    s_add_u32 s37, s37, s22
    s_mul_i32 s37, s37, 384
    s_waitcnt lgkmcnt(0)
    s_and_b32 s5, s5, 0xffff
    s_mov_b32 s6, 3981312
    s_mov_b32 s7, 0x20000
    s_cmp_eq_u32 s20, 3
    s_cbranch_scc1 K1_LOADER
    buffer_load_dwordx4 v[180:183], v234, s[4:7], s37 offen offset:0
    buffer_load_dwordx4 v[184:187], v234, s[4:7], s37 offen offset:64
    buffer_load_dwordx4 v[188:191], v234, s[4:7], s37 offen offset:128
    buffer_load_dwordx4 v[192:195], v234, s[4:7], s37 offen offset:192
    buffer_load_dwordx4 v[196:199], v234, s[4:7], s37 offen offset:256
    buffer_load_dwordx4 v[200:203], v234, s[4:7], s37 offen offset:320
    s_and_b32 s9, s9, 0xffff
    s_mov_b32 s10, 221184
    s_mov_b32 s11, 0x20000
    s_and_b32 s13, s13, 0xffff
    s_mov_b32 s14, 73728
    s_mov_b32 s15, 0x20000
    s_and_b32 s17, s17, 0xffff
    s_mov_b32 s18, 4587520
    s_mov_b32 s19, 0x20000
    s_mov_b32 s26, 0x2aaaaaab
    s_mul_i32 s27, s20, 96
    v_add_u32 v230, 0, v250
    v_mul_hi_u32 v231, v230, s26
    v_mul_u32_u24 v232, 6, v231
    v_sub_u32 v232, v230, v232
    v_lshlrev_b32 v232, 4, v232
    v_add_u32 v232, s27, v232
    v_mul_u32_u24 v233, 384, v231
    v_add_u32 v243, v233, v232
    v_and_b32 v230, 0x13, v231
    v_and_b32 v233, 4, v231
    v_lshl_or_b32 v230, v233, 1, v230
    v_and_b32 v233, 8, v231
    v_lshrrev_b32 v233, 1, v233
    v_or_b32 v230, v230, v233
    v_mul_u32_u24 v230, 1152, v230
    v_add_u32 v240, v230, v232
    v_add_u32 v230, 64, v250
    v_mul_hi_u32 v231, v230, s26
    v_mul_u32_u24 v232, 6, v231
    v_sub_u32 v232, v230, v232
    v_lshlrev_b32 v232, 4, v232
    v_add_u32 v232, s27, v232
    v_subrev_u32 v232, 1024, v232
    v_mul_u32_u24 v233, 384, v231
    v_add_u32 v244, v233, v232
    v_and_b32 v230, 0x13, v231
    v_and_b32 v233, 4, v231
    v_lshl_or_b32 v230, v233, 1, v230
    v_and_b32 v233, 8, v231
    v_lshrrev_b32 v233, 1, v233
    v_or_b32 v230, v230, v233
    v_mul_u32_u24 v230, 1152, v230
    v_add_u32 v241, v230, v232
    v_add_u32 v230, 128, v250
    v_mul_hi_u32 v231, v230, s26
    v_mul_u32_u24 v232, 6, v231
    v_sub_u32 v232, v230, v232
    v_lshlrev_b32 v232, 4, v232
    v_add_u32 v232, s27, v232
    v_subrev_u32 v232, 2048, v232
    v_mul_u32_u24 v233, 384, v231
    v_add_u32 v245, v233, v232
    v_and_b32 v230, 0x13, v231
    v_and_b32_e64 v233, 4, v231
    v_lshl_or_b32 v230, v233, 1, v230
    v_and_b32 v233, 8, v231
    v_lshrrev_b32 v233, 1, v233
    v_or_b32 v230, v230, v233
    v_mul_u32_u24 v230, 1152, v230
    v_add_u32 v242, v230, v232
    s_add_u32 m0, s21, 0
    s_mov_b32 s35, 0
    buffer_load_dwordx4 v240, s[8:11], s35 offen offset:0 lds
    buffer_load_dwordx4 v241, s[8:11], s35 offen offset:1024 lds
    buffer_load_dwordx4 v242, s[8:11], s35 offen offset:2048 lds
    s_add_u32 m0, s21, 3072
    s_mov_b32 s28, 36864
    buffer_load_dwordx4 v240, s[8:11], s28 offen offset:0 lds
    buffer_load_dwordx4 v241, s[8:11], s28 offen offset:1024 lds
    buffer_load_dwordx4 v242, s[8:11], s28 offen offset:2048 lds
    v_lshrrev_b32 v230, 1, v252
    v_lshlrev_b32 v230, 4, v230
    v_and_b32 v231, 1, v252
    v_lshl_add_u32 v230, v231, 2, v230
    v_lshrrev_b32 v231, 2, v251
    v_add_u32 v230, v230, v231
    v_mul_u32_u24 v230, 96, v230
    v_and_b32 v232, 3, v251
    v_lshl_add_u32 v230, v232, 3, v230
    v_add_u32 v246, s21, v230
    v_lshl_add_u32 v230, v252, 2, v231
    v_mul_u32_u24 v230, 96, v230
    v_add_u32 v230, s21, v230
    v_lshl_add_u32 v247, v232, 4, v230
    v_lshl_add_u32 v248, v232, 3, v230
    v_add_u32 v248, 64, v248
    v_lshrrev_b32 v230, 1, v252
    v_lshrrev_b32 v231, 3, v251
    v_cmp_eq_u32 s[40:41], v230, v231
    s_mul_i32 s24, s20, 6
    v_add_u32 v226, s24, v252
    v_lshrrev_b32 v232, 2, v226
    v_lshlrev_b32 v232, 10, v232
    v_and_b32 v233, 3, v226
    v_lshl_add_u32 v233, v233, 4, v251
    v_lshl_add_u32 v228, v233, 4, v232
    v_add_u32 v228, 129024, v228
    v_lshrrev_b32 v231, 1, v252
    s_add_u32 s24, s24, 4
    v_add_u32 v227, s24, v231
    v_lshrrev_b32 v232, 2, v227
    v_lshlrev_b32 v232, 10, v232
    v_and_b32 v233, 3, v227
    v_lshl_add_u32 v233, v233, 4, v251
    v_lshl_add_u32 v229, v233, 4, v232
    v_add_u32 v229, 129024, v229
    v_and_b32_e64 v232, 1, v252
    v_lshl_add_u32 v229, v232, 3, v229
    s_mov_b32 s33, 129024
    s_mul_i32 s34, s20, 800
    s_add_u32 s34, s34, 129024
    s_mul_i32 s42, s20, 1007616
    s_add_u32 s43, s42, 4096
    s_add_u32 s44, s42, 8192
    s_add_u32 s45, s42, 503808
    s_add_u32 s46, s42, 507904
    s_add_u32 s47, s42, 512000
    s_mul_i32 s31, s20, 20736
    s_add_u32 s31, s31, 4194304
    s_add_u32 s32, s31, 10368
    v_add_u32 v235, 110592, v249
    s_mul_i32 s24, s20, 3072
    s_add_u32 s24, s24, 147456
    v_add_u32 v236, s24, v249
    s_lshl_b32 s24, s23, 10
    s_add_u32 s24, s24, 147456
    v_add_u32 v237, s24, v249
    v_lshlrev_b32 v211, 3, v250
    v_add_u32 v211, 159744, v211
    s_lshl_b32 s24, s23, 9
    v_add_u32_e64 v210, s24, v211
    s_mul_i32 s24, s20, 3
    s_add_u32 s24, s24, 0
    s_lshr_b32 s25, s24, 1
    s_lshl_b32 s25, s25, 10
    s_and_b32 s24, s24, 1
    s_lshl_b32 s24, s24, 3
    s_add_u32 s24, s24, s25
    s_add_u32 s24, s24, 110592
    v_add_u32 v238, s24, v249
    s_mul_i32 s24, s20, 3
    s_add_u32 s24, s24, 1
    s_lshr_b32 s25, s24, 1
    s_lshl_b32 s25, s25, 10
    s_and_b32 s24, s24, 1
    s_lshl_b32 s24, s24, 3
    s_add_u32 s24, s24, s25
    s_add_u32 s24, s24, 110592
    v_add_u32 v239, s24, v249
    s_mul_i32 s24, s20, 3
    s_add_u32 s24, s24, 2
    s_lshr_b32 s25, s24, 1
    s_lshl_b32 s25, s25, 10
    s_and_b32 s24, s24, 1
    s_lshl_b32 s24, s24, 3
    s_add_u32 s24, s24, s25
    s_add_u32 s24, s24, 110592
    v_add_u32 v253, s24, v249
    s_mul_i32 s24, s23, 6144
    s_add_u32 s25, s24, 110592
    s_add_u32 s24, s24, 129024
    s_cmp_eq_u32 s20, 3
    s_cselect_b32 s24, 147456, s24
    v_add_u32 v224, s25, v249
    v_add_u32 v225, s24, v249
    s_mov_b32 s29, 0x3dd53b95
    s_mov_b32 s36, 0x3baaaaab
    v_mov_b32 v76, 0x3f803f80
    v_mov_b32 v77, v76
    v_mov_b32 v78, v76
    v_mov_b32 v79, v76
    v_mov_b32 v80, 0
    v_mov_b32 v81, 0
    s_waitcnt vmcnt(11)
    v_mfma_f32_16x16x32_bf16 v[72:75], v[76:79], v[180:183], 0
    v_dot2c_f32_bf16 v80, v180, v180
    v_dot2c_f32_bf16 v81, v181, v181
    v_dot2c_f32_bf16 v80, v182, v182
    v_dot2c_f32_bf16 v81, v183, v183
    s_waitcnt vmcnt(10)
    v_mfma_f32_16x16x32_bf16 v[72:75], v[76:79], v[184:187], v[72:75]
    v_dot2c_f32_bf16 v80, v184, v184
    v_dot2c_f32_bf16 v81, v185, v185
    v_dot2c_f32_bf16 v80, v186, v186
    v_dot2c_f32_bf16 v81, v187, v187
    s_waitcnt vmcnt(9)
    v_mfma_f32_16x16x32_bf16 v[72:75], v[76:79], v[188:191], v[72:75]
    v_dot2c_f32_bf16 v80, v188, v188
    v_dot2c_f32_bf16 v81, v189, v189
    v_dot2c_f32_bf16 v80, v190, v190
    v_dot2c_f32_bf16 v81, v191, v191
    s_waitcnt vmcnt(8)
    v_mfma_f32_16x16x32_bf16 v[72:75], v[76:79], v[192:195], v[72:75]
    v_dot2c_f32_bf16 v80, v192, v192
    v_dot2c_f32_bf16 v81, v193, v193
    v_dot2c_f32_bf16 v80, v194, v194
    v_dot2c_f32_bf16 v81, v195, v195
    s_waitcnt vmcnt(7)
    v_mfma_f32_16x16x32_bf16 v[72:75], v[76:79], v[196:199], v[72:75]
    v_dot2c_f32_bf16 v80, v196, v196
    v_dot2c_f32_bf16 v81, v197, v197
    v_dot2c_f32_bf16 v80, v198, v198
    v_dot2c_f32_bf16 v81, v199, v199
    s_waitcnt vmcnt(6)
    v_mfma_f32_16x16x32_bf16 v[72:75], v[76:79], v[200:203], v[72:75]
    v_dot2c_f32_bf16 v80, v200, v200
    v_dot2c_f32_bf16 v81, v201, v201
    v_dot2c_f32_bf16 v80, v202, v202
    v_dot2c_f32_bf16 v81, v203, v203
    s_nop 2
    v_add_f32 v80, v80, v81
    v_lshlrev_b32 v24, 16, v180
    v_lshlrev_b32 v26, 16, v181
    v_lshlrev_b32 v28, 16, v182
    v_lshlrev_b32 v30, 16, v183
    v_mov_b32 v82, v80
    v_and_b32 v25, 0xffff0000, v180
    v_and_b32 v27, 0xffff0000, v181
    ds_write_b128 v225, v[180:183] offset:0
    v_and_b32 v29, 0xffff0000, v182
    v_and_b32 v31, 0xffff0000, v183
    v_permlane16_swap_b32 v80, v82
    v_add_f32 v80, v80, v82
    s_add_u32 m0, s21, 6144
    s_mov_b32 s35, 73728
    buffer_load_dwordx4 v240, s[8:11], s35 offen offset:0 lds
    v_mul_f32 v72, 0x3baaaaab, v72
    v_mov_b32 v82, v80
    v_lshlrev_b32 v32, 16, v184
    v_and_b32 v33, 0xffff0000, v184
    ds_write_b128 v225, v[184:187] offset:1024
    v_permlane32_swap_b32 v80, v82
    v_add_f32 v80, v80, v82
    v_mul_f32 v82, v72, v72
    v_fma_f32 v80, v80, s36, -v82
    v_max_f32 v80, 0, v80
    v_add_f32 v80, 0x3727c5ac, v80
    v_rsq_f32 v80, v80
    v_lshlrev_b32 v34, 16, v185
    ds_write_b128 v225, v[188:191] offset:2048
    buffer_load_dwordx4 v241, s[8:11], s35 offen offset:1024 lds
    v_and_b32 v35, 0xffff0000, v185
    v_lshlrev_b32 v36, 16, v186
    v_and_b32 v37, 0xffff0000, v186
    v_lshlrev_b32 v38, 16, v187
    v_and_b32 v39, 0xffff0000, v187
    v_mul_f32 v82, v72, v80
    v_sub_f32 v82, 0, v82
    v_pk_fma_f32 v[24:25], v[24:25], v[80:81], v[82:83] op_sel_hi:[1,0,0]
    ds_write_b128 v225, v[192:195] offset:3072
    v_cvt_pk_bf16_f32 v84, v24, v25
    v_pk_fma_f32 v[26:27], v[26:27], v[80:81], v[82:83] op_sel_hi:[1,0,0]
    v_cvt_pk_bf16_f32 v85, v26, v27
    v_pk_fma_f32 v[28:29], v[28:29], v[80:81], v[82:83] op_sel_hi:[1,0,0]
    buffer_load_dwordx4 v242, s[8:11], s35 offen offset:2048 lds
    v_cvt_pk_bf16_f32 v86, v28, v29
    v_pk_fma_f32 v[30:31], v[30:31], v[80:81], v[82:83] op_sel_hi:[1,0,0]
    v_cvt_pk_bf16_f32 v87, v30, v31
    ds_write_b128 v224, v[84:87] offset:0
    ds_write_b128 v225, v[196:199] offset:4096
    v_pk_fma_f32 v[32:33], v[32:33], v[80:81], v[82:83] op_sel_hi:[1,0,0]
    v_cvt_pk_bf16_f32 v88, v32, v33
    v_pk_fma_f32 v[34:35], v[34:35], v[80:81], v[82:83] op_sel_hi:[1,0,0]
    v_cvt_pk_bf16_f32 v89, v34, v35
    v_pk_fma_f32 v[36:37], v[36:37], v[80:81], v[82:83] op_sel_hi:[1,0,0]
    v_cvt_pk_bf16_f32 v90, v36, v37
    v_pk_fma_f32 v[38:39], v[38:39], v[80:81], v[82:83] op_sel_hi:[1,0,0]
    v_cvt_pk_bf16_f32 v91, v38, v39
    ds_write_b128 v225, v[200:203] offset:5120
    s_add_u32 m0, s21, 9216
    s_mov_b32 s28, 110592
    buffer_load_dwordx4 v240, s[8:11], s28 offen offset:0 lds
    ds_write_b128 v224, v[88:91] offset:1024
    v_lshlrev_b32 v40, 16, v188
    v_and_b32 v41, 0xffff0000, v188
    v_pk_fma_f32 v[40:41], v[40:41], v[80:81], v[82:83] op_sel_hi:[1,0,0]
    v_cvt_pk_bf16_f32 v92, v40, v41
    v_lshlrev_b32 v42, 16, v189
    v_and_b32 v43, 0xffff0000, v189
    v_pk_fma_f32 v[42:43], v[42:43], v[80:81], v[82:83] op_sel_hi:[1,0,0]
    v_cvt_pk_bf16_f32 v93, v42, v43
    v_lshlrev_b32 v44, 16, v190
    v_and_b32 v45, 0xffff0000, v190
    v_pk_fma_f32 v[44:45], v[44:45], v[80:81], v[82:83] op_sel_hi:[1,0,0]
    buffer_load_dwordx4 v241, s[8:11], s28 offen offset:1024 lds
    v_cvt_pk_bf16_f32 v94, v44, v45
    v_lshlrev_b32 v46, 16, v191
    v_and_b32 v47, 0xffff0000, v191
    v_pk_fma_f32 v[46:47], v[46:47], v[80:81], v[82:83] op_sel_hi:[1,0,0]
    v_cvt_pk_bf16_f32 v95, v46, v47
    ds_write_b128 v224, v[92:95] offset:2048
    v_lshlrev_b32 v48, 16, v192
    v_and_b32 v49, 0xffff0000, v192
    v_pk_fma_f32 v[48:49], v[48:49], v[80:81], v[82:83] op_sel_hi:[1,0,0]
    v_cvt_pk_bf16_f32 v96, v48, v49
    v_lshlrev_b32 v50, 16, v193
    v_and_b32 v51, 0xffff0000, v193
    buffer_load_dwordx4 v242, s[8:11], s28 offen offset:2048 lds
    v_pk_fma_f32 v[50:51], v[50:51], v[80:81], v[82:83] op_sel_hi:[1,0,0]
    v_cvt_pk_bf16_f32 v97, v50, v51
    v_lshlrev_b32 v52, 16, v194
    v_and_b32 v53, 0xffff0000, v194
    v_pk_fma_f32 v[52:53], v[52:53], v[80:81], v[82:83] op_sel_hi:[1,0,0]
    v_cvt_pk_bf16_f32 v98, v52, v53
    v_lshlrev_b32 v54, 16, v195
    v_and_b32 v55, 0xffff0000, v195
    v_pk_fma_f32 v[54:55], v[54:55], v[80:81], v[82:83] op_sel_hi:[1,0,0]
    v_cvt_pk_bf16_f32 v99, v54, v55
    ds_write_b128 v224, v[96:99] offset:3072
    v_lshlrev_b32 v56, 16, v196
    v_and_b32 v57, 0xffff0000, v196
    v_pk_fma_f32 v[56:57], v[56:57], v[80:81], v[82:83] op_sel_hi:[1,0,0]
    v_cvt_pk_bf16_f32 v100, v56, v57
    v_lshlrev_b32 v58, 16, v197
    v_and_b32 v59, 0xffff0000, v197
    v_pk_fma_f32 v[58:59], v[58:59], v[80:81], v[82:83] op_sel_hi:[1,0,0]
    v_cvt_pk_bf16_f32 v101, v58, v59
    v_lshlrev_b32 v60, 16, v198
    v_and_b32 v61, 0xffff0000, v198
    v_pk_fma_f32 v[60:61], v[60:61], v[80:81], v[82:83] op_sel_hi:[1,0,0]
    v_cvt_pk_bf16_f32 v102, v60, v61
    v_lshlrev_b32 v62, 16, v199
    v_and_b32 v63, 0xffff0000, v199
    v_pk_fma_f32 v[62:63], v[62:63], v[80:81], v[82:83] op_sel_hi:[1,0,0]
    v_cvt_pk_bf16_f32 v103, v62, v63
    ds_write_b128 v224, v[100:103] offset:4096
    v_lshlrev_b32 v64, 16, v200
    v_and_b32 v65, 0xffff0000, v200
    v_pk_fma_f32 v[64:65], v[64:65], v[80:81], v[82:83] op_sel_hi:[1,0,0]
    v_cvt_pk_bf16_f32 v104, v64, v65
    v_lshlrev_b32 v66, 16, v201
    v_and_b32 v67, 0xffff0000, v201
    v_pk_fma_f32 v[66:67], v[66:67], v[80:81], v[82:83] op_sel_hi:[1,0,0]
    v_cvt_pk_bf16_f32 v105, v66, v67
    v_lshlrev_b32_e64 v68, 16, v202
    v_and_b32 v69, 0xffff0000, v202
    v_pk_fma_f32 v[68:69], v[68:69], v[80:81], v[82:83] op_sel_hi:[1,0,0]
    v_cvt_pk_bf16_f32 v106, v68, v69
    v_lshlrev_b32 v70, 16, v203
    v_and_b32 v71, 0xffff0000, v203
    v_pk_fma_f32 v[70:71], v[70:71], v[80:81], v[82:83] op_sel_hi:[1,0,0]
    v_cvt_pk_bf16_f32 v107, v70, v71
    ds_write_b128 v224, v[104:107] offset:5120
    s_waitcnt lgkmcnt(0)
    s_branch K1_JOIN
K1_LOADER:
    s_lshr_b32 s38, s2, 3
    s_and_b32 s9, s9, 0xffff
    s_mov_b32 s10, 221184
    s_mov_b32 s11, 0x20000
    s_and_b32 s13, s13, 0xffff
    s_mov_b32 s14, 73728
    s_mov_b32 s15, 0x20000
    s_and_b32 s17, s17, 0xffff
    s_mov_b32 s18, 4587520
    s_mov_b32 s19, 0x20000
    s_mov_b32 s26, 0x2aaaaaab
    s_mul_i32 s27, s20, 96
    v_add_u32 v230, 0, v250
    v_mul_hi_u32 v231, v230, s26
    v_mul_u32_u24 v232, 6, v231
    v_sub_u32 v232, v230, v232
    v_lshlrev_b32 v232, 4, v232
    v_add_u32_e64 v232, s27, v232
    v_mul_u32_u24 v233, 384, v231
    v_add_u32 v243, v233, v232
    v_and_b32 v230, 0x13, v231
    v_and_b32 v233, 4, v231
    v_lshl_or_b32 v230, v233, 1, v230
    v_and_b32 v233, 8, v231
    v_lshrrev_b32 v233, 1, v233
    v_or_b32 v230, v230, v233
    v_mul_u32_u24 v230, 1152, v230
    v_add_u32 v240, v230, v232
    v_add_u32 v230, 64, v250
    v_mul_hi_u32 v231, v230, s26
    v_mul_u32_u24 v232, 6, v231
    v_sub_u32 v232, v230, v232
    v_lshlrev_b32 v232, 4, v232
    v_add_u32 v232, s27, v232
    v_subrev_u32 v232, 1024, v232
    v_mul_u32_u24 v233, 384, v231
    v_add_u32 v244, v233, v232
    v_and_b32 v230, 0x13, v231
    v_and_b32 v233, 4, v231
    v_lshl_or_b32 v230, v233, 1, v230
    v_and_b32 v233, 8, v231
    v_lshrrev_b32 v233, 1, v233
    v_or_b32 v230, v230, v233
    v_mul_u32_u24 v230, 1152, v230
    v_add_u32 v241, v230, v232
    v_add_u32 v230, 128, v250
    v_mul_hi_u32 v231, v230, s26
    v_mul_u32_u24 v232, 6, v231
    v_sub_u32 v232, v230, v232
    v_lshlrev_b32 v232, 4, v232
    v_add_u32 v232, s27, v232
    v_subrev_u32 v232, 2048, v232
    v_mul_u32_u24 v233, 384, v231
    v_add_u32 v245, v233, v232
    v_and_b32 v230, 0x13, v231
    v_and_b32 v233, 4, v231
    v_lshl_or_b32 v230, v233, 1, v230
    v_and_b32 v233, 8, v231
    v_lshrrev_b32 v233, 1, v233
    v_or_b32 v230, v230, v233
    v_mul_u32_u24 v230, 1152, v230
    v_add_u32 v242, v230, v232
    s_add_u32 m0, s21, 0
    s_mov_b32 s35, 0
    buffer_load_dwordx4 v240, s[8:11], s35 offen offset:0 lds
    buffer_load_dwordx4 v241, s[8:11], s35 offen offset:1024 lds
    buffer_load_dwordx4 v242, s[8:11], s35 offen offset:2048 lds
    s_add_u32 m0, s21, 3072
    s_mov_b32 s28, 36864
    buffer_load_dwordx4 v240, s[8:11], s28 offen offset:0 lds
    buffer_load_dwordx4 v241, s[8:11], s28 offen offset:1024 lds
    buffer_load_dwordx4 v242, s[8:11], s28 offen offset:2048 lds
    s_lshl_b32 s39, s38, 6
    v_add_u32 v4, s39, v250
    v_lshlrev_b32_e64 v4, 7, v4
    buffer_load_dword a255, v4, s[8:11], 0 offen
    s_mul_i32 s39, s38, 22
    v_min_u32 v5, 21, v250
    v_add_u32 v5, s39, v5
    v_lshlrev_b32 v5, 7, v5
    buffer_load_dword a254, v5, s[12:15], 0 offen
    s_add_u32 m0, s21, 6144
    s_mov_b32 s35, 73728
    buffer_load_dwordx4 v240, s[8:11], s35 offen offset:0 lds
    buffer_load_dwordx4 v241, s[8:11], s35 offen offset:1024 lds
    buffer_load_dwordx4 v242, s[8:11], s35 offen offset:2048 lds
    v_lshrrev_b32 v230, 1, v252
    v_lshlrev_b32 v230, 4, v230
    v_and_b32 v231, 1, v252
    v_lshl_add_u32 v230, v231, 2, v230
    v_lshrrev_b32 v231, 2, v251
    v_add_u32 v230, v230, v231
    v_mul_u32_u24 v230, 96, v230
    v_and_b32 v232, 3, v251
    v_lshl_add_u32 v230, v232, 3, v230
    v_add_u32_e64 v246, s21, v230
    v_lshl_add_u32 v230, v252, 2, v231
    v_mul_u32_u24 v230, 96, v230
    v_add_u32 v230, s21, v230
    v_lshl_add_u32 v247, v232, 4, v230
    v_lshl_add_u32 v248, v232, 3, v230
    v_add_u32 v248, 64, v248
    v_lshrrev_b32 v230, 1, v252
    v_lshrrev_b32 v231, 3, v251
    v_cmp_eq_u32 s[40:41], v230, v231
    s_mul_i32 s24, s20, 6
    v_add_u32 v226, s24, v252
    v_lshrrev_b32 v232, 2, v226
    v_lshlrev_b32 v232, 10, v232
    v_and_b32 v233, 3, v226
    v_lshl_add_u32 v233, v233, 4, v251
    v_lshl_add_u32 v228, v233, 4, v232
    v_add_u32 v228, 129024, v228
    v_lshrrev_b32 v231, 1, v252
    s_add_u32 s24, s24, 4
    v_add_u32 v227, s24, v231
    v_lshrrev_b32 v232, 2, v227
    v_lshlrev_b32 v232, 10, v232
    v_and_b32_e64 v233, 3, v227
    v_lshl_add_u32 v233, v233, 4, v251
    v_lshl_add_u32 v229, v233, 4, v232
    v_add_u32 v229, 129024, v229
    v_and_b32_e64 v232, 1, v252
    v_lshl_add_u32 v229, v232, 3, v229
    s_mov_b32 s33, 129024
    s_mul_i32 s34, s20, 800
    s_add_u32 s34, s34, 129024
    s_mul_i32 s42, s20, 1007616
    s_add_u32 s43, s42, 4096
    s_add_u32 s44, s42, 8192
    s_add_u32 s45, s42, 503808
    s_add_u32 s46, s42, 507904
    s_add_u32 s47, s42, 512000
    s_mul_i32 s31, s20, 20736
    s_add_u32 s31, s31, 4194304
    s_add_u32 s32, s31, 10368
    v_add_u32 v235, 110592, v249
    s_mul_i32 s24, s20, 3072
    s_add_u32 s24, s24, 147456
    v_add_u32 v236, s24, v249
    s_lshl_b32 s24, s23, 10
    s_add_u32 s24, s24, 147456
    v_add_u32 v237, s24, v249
    v_lshlrev_b32 v211, 3, v250
    v_add_u32 v211, 159744, v211
    s_lshl_b32 s24, s23, 9
    v_add_u32 v210, s24, v211
    s_mul_i32 s24, s20, 3
    s_add_u32 s24, s24, 0
    s_lshr_b32 s25, s24, 1
    s_lshl_b32 s25, s25, 10
    s_and_b32 s24, s24, 1
    s_lshl_b32 s24, s24, 3
    s_add_u32 s24, s24, s25
    s_add_u32 s24, s24, 110592
    v_add_u32 v238, s24, v249
    s_mul_i32 s24, s20, 3
    s_add_u32 s24, s24, 1
    s_lshr_b32 s25, s24, 1
    s_lshl_b32 s25, s25, 10
    s_and_b32 s24, s24, 1
    s_lshl_b32 s24, s24, 3
    s_add_u32 s24, s24, s25
    s_add_u32 s24, s24, 110592
    v_add_u32 v239, s24, v249
    s_mul_i32 s24, s20, 3
    s_add_u32 s24, s24, 2
    s_lshr_b32 s25, s24, 1
    s_lshl_b32 s25, s25, 10
    s_and_b32 s24, s24, 1
    s_lshl_b32 s24, s24, 3
    s_add_u32 s24, s24, s25
    s_add_u32 s24, s24, 110592
    v_add_u32 v253, s24, v249
    s_mul_i32 s24, s23, 6144
    s_add_u32 s25, s24, 110592
    s_add_u32 s24, s24, 129024
    s_cmp_eq_u32 s20, 3
    s_cselect_b32 s24, 147456, s24
    v_add_u32 v224, s25, v249
    v_add_u32_e64 v225, s24, v249
    s_mov_b32 s29, 0x3dd53b95
    s_mov_b32 s36, 0x3baaaaab
    v_mov_b32 v76, 0x3f803f80
    v_mov_b32 v77, v76
    v_mov_b32 v78, v76
    v_mov_b32 v79, v76
    v_mov_b32 v80, 0
    v_mov_b32_e64 v81, 0
    s_add_u32 m0, s21, 9216
    s_mov_b32 s28, 110592
    buffer_load_dwordx4 v240, s[8:11], s28 offen offset:0 lds
    buffer_load_dwordx4 v241, s[8:11], s28 offen offset:1024 lds
    buffer_load_dwordx4 v242, s[8:11], s28 offen offset:2048 lds
K1_JOIN:
    s_barrier
    s_waitcnt vmcnt(9)
    ds_read_b64_tr_b16 a[72:73], v246 offset:0
    ds_read_b64_tr_b16 a[74:75], v246 offset:768
    ds_read_b128 a[0:3], v235 offset:0
    ds_read_b128 a[24:27], v235 offset:6144
    ds_read_b128 a[48:51], v235 offset:12288
    ds_read_b64_tr_b16 a[76:77], v246 offset:32
    ds_read_b64_tr_b16 a[78:79], v246 offset:800
    ds_read_b64_tr_b16 a[80:81], v246 offset:64
    ds_read_b64_tr_b16 a[82:83], v246 offset:832
    s_waitcnt lgkmcnt(6)
    v_mfma_f32_16x16x32_bf16 v[0:3], a[72:75], a[0:3], 0
    s_add_u32 m0, s21, 12288
    s_waitcnt vmcnt(6)
    ds_read_b64_tr_b16 a[84:85], v246 offset:3072
    ds_read_b128 a[4:7], v235 offset:1024
    s_waitcnt lgkmcnt(7)
    v_mfma_f32_16x16x32_bf16 v[4:7], a[72:75], a[24:27], 0
    s_mov_b32 s35, 147456
    ds_read_b64_tr_b16 a[86:87], v246 offset:3840
    s_waitcnt lgkmcnt(7)
    v_mfma_f32_16x16x32_bf16 v[8:11], a[72:75], a[48:51], 0
    s_waitcnt lgkmcnt(5)
    ds_read_b64_tr_b16 a[88:89], v246 offset:3104
    ds_read_b128 a[28:31], v235 offset:7168
    s_nop 0
    buffer_load_dwordx4 v240, s[8:11], s35 offen offset:0 lds
    v_mfma_f32_16x16x32_bf16 v[12:15], a[76:79], a[0:3], 0
    ds_read_b64_tr_b16 a[90:91], v246 offset:3872
    buffer_load_dwordx4 v241, s[8:11], s35 offen offset:1024 lds
    v_mfma_f32_16x16x32_bf16 v[16:19], a[76:79], a[24:27], 0
    ds_read_b64_tr_b16 a[92:93], v246 offset:3136
    ds_read_b128 a[52:55], v235 offset:13312
    v_mfma_f32_16x16x32_bf16 v[20:23], a[76:79], a[48:51], 0
    s_waitcnt lgkmcnt(8)
    ds_read_b64_tr_b16 a[94:95], v246 offset:3904
    buffer_load_dwordx4 v242, s[8:11], s35 offen offset:2048 lds
    v_mfma_f32_16x16x32_bf16 v[24:27], a[80:83], a[0:3], 0
    s_add_u32 m0, s21, 15360
    ds_read_b128 v[144:147], v228 offset:0
    v_mfma_f32_16x16x32_bf16 v[28:31], a[80:83], a[24:27], 0
    s_mov_b32 s28, 184320
    s_nop 0
    ds_read_b64 v[148:149], v229 offset:0
    v_mfma_f32_16x16x32_bf16 v[32:35], a[80:83], a[48:51], 0
    s_waitcnt lgkmcnt(6)
    ds_read_b128 v[150:153], v228 offset:6144
    buffer_load_dwordx4 v240, s[8:11], s28 offen offset:0 lds
    v_mfma_f32_16x16x32_bf16 v[0:3], a[84:87], a[4:7], v[0:3]
    s_waitcnt vmcnt(7)
    ds_read_b64_tr_b16 a[72:73], v246 offset:6144
    ds_read_b128 a[8:11], v235 offset:2048
    v_mfma_f32_16x16x32_bf16 v[4:7], a[84:87], a[28:31], v[4:7]
    ds_read_b64_tr_b16 a[74:75], v246 offset:6912
    s_waitcnt lgkmcnt(7)
    v_mfma_f32_16x16x32_bf16 v[8:11], a[84:87], a[52:55], v[8:11]
    ds_read_b64_tr_b16 a[76:77], v246 offset:6176
    ds_read_b128 a[32:35], v235 offset:8192
    buffer_load_dwordx4 v241, s[8:11], s28 offen offset:1024 lds
    v_mfma_f32_16x16x32_bf16 v[12:15], a[88:91], a[4:7], v[12:15]
    s_nop 0
    ds_read_b64_tr_b16 a[78:79], v246 offset:6944
    buffer_load_dwordx4 v242, s[8:11], s28 offen offset:2048 lds
    v_mfma_f32_16x16x32_bf16 v[16:19], a[88:91], a[28:31], v[16:19]
    s_add_u32 m0, s21, 18432
    ds_read_b64_tr_b16 a[80:81], v246 offset:6208
    ds_read_b128 a[56:59], v235 offset:14336
    v_mfma_f32_16x16x32_bf16 v[20:23], a[88:91], a[52:55], v[20:23]
    s_waitcnt lgkmcnt(11)
    s_nop 0
    s_mov_b32 s35, 384
    ds_read_b64_tr_b16 a[82:83], v246 offset:6976
    buffer_load_dwordx4 v240, s[8:11], s35 offen offset:0 lds
    v_mfma_f32_16x16x32_bf16 v[24:27], a[92:95], a[4:7], v[24:27]
    ds_read_b64 v[154:155], v229 offset:6144
    v_mfma_f32_16x16x32_bf16 v[28:31], a[92:95], a[28:31], v[28:31]
    ds_read_b128 v[156:159], v228 offset:12288
    v_mfma_f32_16x16x32_bf16 v[32:35], a[92:95], a[52:55], v[32:35]
    s_waitcnt lgkmcnt(6)
    ds_read_b64 v[160:161], v229 offset:12288
    buffer_load_dwordx4 v241, s[8:11], s35 offen offset:1024 lds
    v_mfma_f32_16x16x32_bf16 v[0:3], a[72:75], a[8:11], v[0:3]
    s_waitcnt vmcnt(8)
    ds_read_b64_tr_b16 a[84:85], v246 offset:9216
    ds_read_b128 a[12:15], v235 offset:3072
    v_mfma_f32_16x16x32_bf16 v[4:7], a[72:75], a[32:35], v[4:7]
    ds_read_b64_tr_b16 a[86:87], v246 offset:9984
    s_waitcnt lgkmcnt(7)
    v_mfma_f32_16x16x32_bf16 v[8:11], a[72:75], a[56:59], v[8:11]
    ds_read_b64_tr_b16 a[88:89], v246 offset:9248
    ds_read_b128 a[36:39], v235 offset:9216
    buffer_load_dwordx4 v242, s[8:11], s35 offen offset:2048 lds
    v_mfma_f32_16x16x32_bf16 v[12:15], a[76:79], a[8:11], v[12:15]
    s_add_u32 m0, s21, 21504
    ds_read_b64_tr_b16 a[90:91], v246 offset:10016
    s_nop 0
    v_mfma_f32_16x16x32_bf16 v[16:19], a[76:79], a[32:35], v[16:19]
    s_mov_b32 s28, 37248
    ds_read_b64_tr_b16 a[92:93], v246 offset:9280
    ds_read_b128 a[60:63], v235 offset:15360
    v_mfma_f32_16x16x32_bf16 v[20:23], a[76:79], a[56:59], v[20:23]
    s_waitcnt lgkmcnt(11)
    ds_read_b64_tr_b16 a[94:95], v246 offset:10048
    buffer_load_dwordx4 v240, s[8:11], s28 offen offset:0 lds
    s_nop 0
    v_mfma_f32_16x16x32_bf16 v[24:27], a[80:83], a[8:11], v[24:27]
    v_mfma_f32_16x16x32_bf16 v[28:31], a[80:83], a[32:35], v[28:31]
    v_mfma_f32_16x16x32_bf16 v[32:35], a[80:83], a[56:59], v[32:35]
    s_waitcnt lgkmcnt(4)
    buffer_load_dwordx4 v241, s[8:11], s28 offen offset:1024 lds
    v_mfma_f32_16x16x32_bf16 v[0:3], a[84:87], a[12:15], v[0:3]
    s_waitcnt vmcnt(8)
    ds_read_b64_tr_b16 a[72:73], v246 offset:12288
    ds_read_b128 a[16:19], v235 offset:4096
    v_mfma_f32_16x16x32_bf16 v[4:7], a[84:87], a[36:39], v[4:7]
    ds_read_b64_tr_b16 a[74:75], v246 offset:13056
    v_lshlrev_b32 v108, 16, v144
    s_waitcnt lgkmcnt(4)
    v_mfma_f32_16x16x32_bf16 v[8:11], a[84:87], a[60:63], v[8:11]
    ds_read_b64_tr_b16 a[76:77], v246 offset:12320
    ds_read_b128 a[40:43], v235 offset:10240
    buffer_load_dwordx4 v242, s[8:11], s28 offen offset:2048 lds
    v_mfma_f32_16x16x32_bf16 v[12:15], a[88:91], a[12:15], v[12:15]
    s_add_u32 m0, s21, 24576
    ds_read_b64_tr_b16 a[78:79], v246 offset:13088
    v_and_b32 v109, 0xffff0000, v144
    v_mfma_f32_16x16x32_bf16 v[16:19], a[88:91], a[36:39], v[16:19]
    s_mov_b32 s35, 74112
    ds_read_b64_tr_b16 a[80:81], v246 offset:12352
    ds_read_b128 a[64:67], v235 offset:16384
    v_mfma_f32_16x16x32_bf16 v[20:23], a[88:91], a[60:63], v[20:23]
    s_waitcnt lgkmcnt(8)
    ds_read_b64_tr_b16 a[82:83], v246 offset:13120
    buffer_load_dwordx4 v240, s[8:11], s35 offen offset:0 lds
    v_mfma_f32_16x16x32_bf16 v[24:27], a[92:95], a[12:15], v[24:27]
    v_lshlrev_b32 v110, 16, v145
    v_and_b32 v111, 0xffff0000, v145
    v_mfma_f32_16x16x32_bf16 v[28:31], a[92:95], a[36:39], v[28:31]
    v_lshlrev_b32_e64 v112, 16, v146
    v_and_b32 v113, 0xffff0000, v146
    v_mfma_f32_16x16x32_bf16 v[32:35], a[92:95], a[60:63], v[32:35]
    s_waitcnt lgkmcnt(4)
    buffer_load_dwordx4 v241, s[8:11], s35 offen offset:1024 lds
    v_lshlrev_b32_e64 v114, 16, v147
    v_mfma_f32_16x16x32_bf16 v[0:3], a[72:75], a[16:19], v[0:3]
    s_waitcnt vmcnt(8)
    ds_read_b64_tr_b16 a[84:85], v246 offset:15360
    ds_read_b128 a[20:23], v235 offset:5120
    v_mfma_f32_16x16x32_bf16 v[4:7], a[72:75], a[40:43], v[4:7]
    ds_read_b64_tr_b16 a[86:87], v246 offset:16128
    v_and_b32 v115, 0xffff0000, v147
    s_waitcnt lgkmcnt(4)
    v_mfma_f32_16x16x32_bf16 v[8:11], a[72:75], a[64:67], v[8:11]
    ds_read_b64_tr_b16 a[88:89], v246 offset:15392
    ds_read_b128 a[44:47], v235 offset:11264
    buffer_load_dwordx4 v242, s[8:11], s35 offen offset:2048 lds
    v_mfma_f32_16x16x32_bf16 v[12:15], a[76:79], a[16:19], v[12:15]
    s_add_u32 m0, s21, 0
    ds_read_b64_tr_b16 a[90:91], v246 offset:16160
    v_lshlrev_b32 v116, 16, v148
    v_mfma_f32_16x16x32_bf16 v[16:19], a[76:79], a[40:43], v[16:19]
    s_mov_b32 s28, 110976
    ds_read_b64_tr_b16 a[92:93], v246 offset:15424
    ds_read_b128 a[68:71], v235 offset:17408
    v_mfma_f32_16x16x32_bf16 v[20:23], a[76:79], a[64:67], v[20:23]
    s_waitcnt lgkmcnt(8)
    ds_read_b64_tr_b16 a[94:95], v246 offset:16192
    buffer_load_dwordx4 v240, s[8:11], s28 offen offset:0 lds
    v_mfma_f32_16x16x32_bf16 v[24:27], a[80:83], a[16:19], v[24:27]
    v_and_b32 v117, 0xffff0000, v148
    v_lshlrev_b32 v118, 16, v149
    v_mfma_f32_16x16x32_bf16 v[28:31], a[80:83], a[40:43], v[28:31]
    v_and_b32 v119, 0xffff0000, v149
    v_lshlrev_b32_e64 v120, 16, v150
    v_mfma_f32_16x16x32_bf16 v[32:35], a[80:83], a[64:67], v[32:35]
    s_waitcnt lgkmcnt(4)
    buffer_load_dwordx4 v241, s[8:11], s28 offen offset:1024 lds
    v_and_b32 v121, 0xffff0000, v150
    v_mfma_f32_16x16x32_bf16 v[0:3], a[84:87], a[20:23], v[0:3]
    s_waitcnt vmcnt(8)
    ds_read_b64_tr_b16 a[72:73], v246 offset:18432
    v_lshlrev_b32 v122, 16, v151
    v_mfma_f32_16x16x32_bf16 v[4:7], a[84:87], a[44:47], v[4:7]
    ds_read_b64_tr_b16 a[74:75], v246 offset:19200
    v_and_b32 v123, 0xffff0000, v151
    s_waitcnt lgkmcnt(3)
    v_mfma_f32_16x16x32_bf16 v[8:11], a[84:87], a[68:71], v[8:11]
    ds_read_b64_tr_b16 a[76:77], v246 offset:18464
    buffer_load_dwordx4 v242, s[8:11], s28 offen offset:2048 lds
    v_mfma_f32_16x16x32_bf16 v[12:15], a[88:91], a[20:23], v[12:15]
    s_add_u32 m0, s21, 3072
    ds_read_b64_tr_b16 a[78:79], v246 offset:19232
    v_lshlrev_b32 v124, 16, v152
    v_mfma_f32_16x16x32_bf16 v[16:19], a[88:91], a[44:47], v[16:19]
    s_mov_b32 s35, 147840
    ds_read_b64_tr_b16 a[80:81], v246 offset:18496
    v_and_b32 v125, 0xffff0000, v152
    v_mfma_f32_16x16x32_bf16 v[20:23], a[88:91], a[68:71], v[20:23]
    s_waitcnt lgkmcnt(5)
    ds_read_b64_tr_b16 a[82:83], v246 offset:19264
    buffer_load_dwordx4 v240, s[8:11], s35 offen offset:0 lds
    v_mfma_f32_16x16x32_bf16 v[24:27], a[92:95], a[20:23], v[24:27]
    v_lshlrev_b32 v126, 16, v153
    v_and_b32 v127, 0xffff0000, v153
    v_mfma_f32_16x16x32_bf16 v[28:31], a[92:95], a[44:47], v[28:31]
    v_lshlrev_b32 v128, 16, v154
    v_and_b32 v129, 0xffff0000, v154
    v_mfma_f32_16x16x32_bf16 v[32:35], a[92:95], a[68:71], v[32:35]
    s_waitcnt lgkmcnt(4)
    buffer_load_dwordx4 v241, s[8:11], s35 offen offset:1024 lds
    v_lshlrev_b32 v130, 16, v155
    v_mfma_f32_16x16x32_bf16 v[36:39], a[72:75], a[0:3], 0
    s_waitcnt vmcnt(8)
    ds_read_b64_tr_b16 a[84:85], v246 offset:21504
    v_cvt_pk_bf16_f32 v0, v0, v1
    v_mfma_f32_16x16x32_bf16 v[40:43], a[72:75], a[24:27], 0
    ds_read_b64_tr_b16 a[86:87], v246 offset:22272
    v_cvt_pk_bf16_f32 v1, v2, v3
    v_mfma_f32_16x16x32_bf16 v[44:47], a[72:75], a[48:51], 0
    s_waitcnt lgkmcnt(4)
    ds_read_b64_tr_b16 a[88:89], v246 offset:21536
    s_nop 0
    buffer_load_dwordx4 v242, s[8:11], s35 offen offset:2048 lds
    v_mfma_f32_16x16x32_bf16 v[48:51], a[76:79], a[0:3], 0
    s_add_u32 m0, s21, 6144
    ds_read_b64_tr_b16 a[90:91], v246 offset:22304
    v_cvt_pk_bf16_f32 v12, v12, v13
    v_mfma_f32_16x16x32_bf16 v[52:55], a[76:79], a[24:27], 0
    s_mov_b32 s28, 184704
    ds_read_b64_tr_b16 a[92:93], v246 offset:21568
    v_cvt_pk_bf16_f32 v13, v14, v15
    v_mfma_f32_16x16x32_bf16 v[56:59], a[76:79], a[48:51], 0
    s_waitcnt lgkmcnt(5)
    ds_read_b64_tr_b16 a[94:95], v246 offset:22336
    buffer_load_dwordx4 v240, s[8:11], s28 offen offset:0 lds
    v_mfma_f32_16x16x32_bf16 v[60:63], a[80:83], a[0:3], 0
    v_cvt_pk_bf16_f32 v24, v24, v25
    v_cvt_pk_bf16_f32 v25, v26, v27
    s_nop 0
    v_mfma_f32_16x16x32_bf16 v[64:67], a[80:83], a[24:27], 0
    v_cvt_pk_bf16_f32 v4, v4, v5
    v_cvt_pk_bf16_f32 v5, v6, v7
    v_mfma_f32_16x16x32_bf16 v[68:71], a[80:83], a[48:51], 0
    s_waitcnt lgkmcnt(4)
    buffer_load_dwordx4 v241, s[8:11], s28 offen offset:1024 lds
    v_cvt_pk_bf16_f32 v16, v16, v17
    v_mfma_f32_16x16x32_bf16 v[36:39], a[84:87], a[4:7], v[36:39]
    s_waitcnt vmcnt(8)
    ds_read_b64_tr_b16 a[72:73], v246 offset:24576
    v_cvt_pk_bf16_f32 v17, v18, v19
    v_mfma_f32_16x16x32_bf16 v[40:43], a[84:87], a[28:31], v[40:43]
    ds_read_b64_tr_b16 a[74:75], v246 offset:25344
    v_cvt_pk_bf16_f32 v28, v28, v29
    v_mfma_f32_16x16x32_bf16 v[44:47], a[84:87], a[52:55], v[44:47]
    s_waitcnt lgkmcnt(4)
    ds_read_b64_tr_b16 a[76:77], v246 offset:24608
    s_nop 0
    buffer_load_dwordx4 v242, s[8:11], s28 offen offset:2048 lds
    v_mfma_f32_16x16x32_bf16 v[48:51], a[88:91], a[4:7], v[48:51]
    s_add_u32 m0, s21, 9216
    ds_read_b64_tr_b16 a[78:79], v246 offset:25376
    v_cvt_pk_bf16_f32 v29, v30, v31
    v_mfma_f32_16x16x32_bf16 v[52:55], a[88:91], a[28:31], v[52:55]
    s_mov_b32 s35, 768
    ds_read_b64_tr_b16 a[80:81], v246 offset:24640
    v_cvt_pk_bf16_f32 v8, v8, v9
    v_mfma_f32_16x16x32_bf16 v[56:59], a[88:91], a[52:55], v[56:59]
    s_waitcnt lgkmcnt(5)
    ds_read_b64_tr_b16 a[82:83], v246 offset:25408
    buffer_load_dwordx4 v240, s[8:11], s35 offen offset:0 lds
    v_mfma_f32_16x16x32_bf16 v[60:63], a[92:95], a[4:7], v[60:63]
    v_cvt_pk_bf16_f32 v9, v10, v11
    v_cvt_pk_bf16_f32 v20, v20, v21
    s_nop 0
    v_mfma_f32_16x16x32_bf16 v[64:67], a[92:95], a[28:31], v[64:67]
    v_cvt_pk_bf16_f32 v21, v22, v23
    v_cvt_pk_bf16_f32 v32, v32, v33
    v_mfma_f32_16x16x32_bf16 v[68:71], a[92:95], a[52:55], v[68:71]
    s_waitcnt lgkmcnt(4)
    buffer_load_dwordx4 v241, s[8:11], s35 offen offset:1024 lds
    v_cvt_pk_bf16_f32 v33, v34, v35
    v_mfma_f32_16x16x32_bf16 v[36:39], a[72:75], a[8:11], v[36:39]
    s_waitcnt vmcnt(8)
    ds_read_b64_tr_b16 a[84:85], v246 offset:0
    v_and_b32 v131, 0xffff0000, v155
    v_mfma_f32_16x16x32_bf16 v[40:43], a[72:75], a[32:35], v[40:43]
    ds_read_b64_tr_b16 a[86:87], v246 offset:768
    v_lshlrev_b32 v132, 16, v156
    v_mfma_f32_16x16x32_bf16 v[44:47], a[72:75], a[56:59], v[44:47]
    s_waitcnt lgkmcnt(4)
    ds_read_b64_tr_b16 a[88:89], v246 offset:32
    buffer_load_dwordx4 v242, s[8:11], s35 offen offset:2048 lds
    v_mfma_f32_16x16x32_bf16 v[48:51], a[76:79], a[8:11], v[48:51]
    s_add_u32 m0, s21, 12288
    ds_read_b64_tr_b16 a[90:91], v246 offset:800
    v_and_b32 v133, 0xffff0000, v156
    v_mfma_f32_16x16x32_bf16 v[52:55], a[76:79], a[32:35], v[52:55]
    s_mov_b32 s28, 37632
    ds_read_b64_tr_b16 a[92:93], v246 offset:64
    v_lshlrev_b32_e64 v134, 16, v157
    v_mfma_f32_16x16x32_bf16 v[56:59], a[76:79], a[56:59], v[56:59]
    s_waitcnt lgkmcnt(5)
    ds_read_b64_tr_b16 a[94:95], v246 offset:832
    buffer_load_dwordx4 v240, s[8:11], s28 offen offset:0 lds
    v_mfma_f32_16x16x32_bf16 v[60:63], a[80:83], a[8:11], v[60:63]
    v_and_b32 v135, 0xffff0000, v157
    v_lshlrev_b32 v136, 16, v158
    v_mfma_f32_16x16x32_bf16 v[64:67], a[80:83], a[32:35], v[64:67]
    v_and_b32 v137, 0xffff0000, v158
    v_lshlrev_b32 v138, 16, v159
    v_mfma_f32_16x16x32_bf16 v[68:71], a[80:83], a[56:59], v[68:71]
    s_waitcnt lgkmcnt(4)
    buffer_load_dwordx4 v241, s[8:11], s28 offen offset:1024 lds
    v_and_b32 v139, 0xffff0000, v159
    v_mfma_f32_16x16x32_bf16 v[36:39], a[84:87], a[12:15], v[36:39]
    s_waitcnt vmcnt(8)
    ds_read_b64_tr_b16 a[72:73], v246 offset:3072
    v_lshlrev_b32 v140, 16, v160
    v_mfma_f32_16x16x32_bf16 v[40:43], a[84:87], a[36:39], v[40:43]
    ds_read_b64_tr_b16 a[74:75], v246 offset:3840
    v_and_b32 v141, 0xffff0000, v160
    v_mfma_f32_16x16x32_bf16 v[44:47], a[84:87], a[60:63], v[44:47]
    s_waitcnt lgkmcnt(4)
    ds_read_b64_tr_b16 a[76:77], v246 offset:3104
    buffer_load_dwordx4 v242, s[8:11], s28 offen offset:2048 lds
    v_mfma_f32_16x16x32_bf16 v[48:51], a[88:91], a[12:15], v[48:51]
    s_add_u32 m0, s21, 15360
    s_nop 0
    ds_read_b64_tr_b16 a[78:79], v246 offset:3872
    v_lshlrev_b32 v142, 16, v161
    v_mfma_f32_16x16x32_bf16 v[52:55], a[88:91], a[36:39], v[52:55]
    s_mov_b32 s35, 74496
    ds_read_b64_tr_b16 a[80:81], v246 offset:3136
    v_and_b32 v143, 0xffff0000, v161
    v_mfma_f32_16x16x32_bf16 v[56:59], a[88:91], a[60:63], v[56:59]
    s_waitcnt lgkmcnt(5)
    ds_read_b64_tr_b16 a[82:83], v246 offset:3904
    buffer_load_dwordx4 v240, s[8:11], s35 offen offset:0 lds
    v_mfma_f32_16x16x32_bf16 v[60:63], a[92:95], a[12:15], v[60:63]
    v_mfma_f32_16x16x32_bf16 v[64:67], a[92:95], a[36:39], v[64:67]
    v_mfma_f32_16x16x32_bf16 v[68:71], a[92:95], a[60:63], v[68:71]
    s_waitcnt lgkmcnt(4)
    buffer_load_dwordx4 v241, s[8:11], s35 offen offset:1024 lds
    v_mfma_f32_16x16x32_bf16 v[36:39], a[72:75], a[16:19], v[36:39]
    s_waitcnt vmcnt(8)
    ds_read_b64_tr_b16 a[84:85], v246 offset:6144
    v_mfma_f32_16x16x32_bf16 v[40:43], a[72:75], a[40:43], v[40:43]
    ds_read_b64_tr_b16 a[86:87], v246 offset:6912
    v_mfma_f32_16x16x32_bf16 v[44:47], a[72:75], a[64:67], v[44:47]
    s_waitcnt lgkmcnt(4)
    ds_read_b64_tr_b16 a[88:89], v246 offset:6176
    buffer_load_dwordx4 v242, s[8:11], s35 offen offset:2048 lds
    v_mfma_f32_16x16x32_bf16 v[48:51], a[76:79], a[16:19], v[48:51]
    s_add_u32 m0, s21, 18432
    s_nop 0
    ds_read_b64_tr_b16 a[90:91], v246 offset:6944
    v_mfma_f32_16x16x32_bf16 v[52:55], a[76:79], a[40:43], v[52:55]
    s_mov_b32 s28, 111360
    ds_read_b64_tr_b16 a[92:93], v246 offset:6208
    v_mfma_f32_16x16x32_bf16 v[56:59], a[76:79], a[64:67], v[56:59]
    s_waitcnt lgkmcnt(5)
    ds_read_b64_tr_b16 a[94:95], v246 offset:6976
    buffer_load_dwordx4 v240, s[8:11], s28 offen offset:0 lds
    s_nop 0
    v_mfma_f32_16x16x32_bf16 v[60:63], a[80:83], a[16:19], v[60:63]
    v_mfma_f32_16x16x32_bf16 v[64:67], a[80:83], a[40:43], v[64:67]
    v_mfma_f32_16x16x32_bf16 v[68:71], a[80:83], a[64:67], v[68:71]
    s_waitcnt lgkmcnt(4)
    buffer_load_dwordx4 v241, s[8:11], s28 offen offset:1024 lds
    v_mfma_f32_16x16x32_bf16 v[36:39], a[84:87], a[20:23], v[36:39]
    s_waitcnt vmcnt(8)
    ds_read_b64_tr_b16 a[72:73], v246 offset:9216
    v_mfma_f32_16x16x32_bf16 v[40:43], a[84:87], a[44:47], v[40:43]
    ds_read_b64_tr_b16 a[74:75], v246 offset:9984
    v_mfma_f32_16x16x32_bf16 v[44:47], a[84:87], a[68:71], v[44:47]
    s_waitcnt lgkmcnt(4)
    ds_read_b64_tr_b16 a[76:77], v246 offset:9248
    buffer_load_dwordx4 v242, s[8:11], s28 offen offset:2048 lds
    v_mfma_f32_16x16x32_bf16 v[48:51], a[88:91], a[20:23], v[48:51]
    s_add_u32 m0, s21, 21504
    ds_read_b64_tr_b16 a[78:79], v246 offset:10016
    s_nop 0
    v_mfma_f32_16x16x32_bf16 v[52:55], a[88:91], a[44:47], v[52:55]
    s_mov_b32 s35, 148224
    ds_read_b64_tr_b16 a[80:81], v246 offset:9280
    v_mfma_f32_16x16x32_bf16 v[56:59], a[88:91], a[68:71], v[56:59]
    s_waitcnt lgkmcnt(5)
    ds_read_b64_tr_b16 a[82:83], v246 offset:10048
    buffer_load_dwordx4 v240, s[8:11], s35 offen offset:0 lds
    v_mfma_f32_16x16x32_bf16 v[60:63], a[92:95], a[20:23], v[60:63]
    s_nop 0
    v_mfma_f32_16x16x32_bf16 v[64:67], a[92:95], a[44:47], v[64:67]
    v_mfma_f32_16x16x32_bf16 v[68:71], a[92:95], a[68:71], v[68:71]
    s_waitcnt lgkmcnt(4)
    buffer_load_dwordx4 v241, s[8:11], s35 offen offset:1024 lds
    v_cvt_pk_bf16_f32 v36, v36, v37
    v_cvt_pk_bf16_f32 v37, v38, v39
    buffer_load_dwordx4 v242, s[8:11], s35 offen offset:2048 lds
    v_cvt_pk_bf16_f32 v40, v40, v41
    s_nop 0
    v_cvt_pk_bf16_f32 v41, v42, v43
    v_cvt_pk_bf16_f32 v44, v44, v45
    v_cvt_pk_bf16_f32 v45, v46, v47
    v_mfma_f32_16x16x16_bf16 v[144:147], v[36:37], v[0:1], 0
    v_mfma_f32_16x16x16_bf16 v[148:151], v[40:41], v[4:5], 0
    v_mfma_f32_16x16x16_bf16 v[152:155], v[44:45], v[8:9], 0
    v_cvt_pk_bf16_f32 v48, v48, v49
    v_cvt_pk_bf16_f32 v49, v50, v51
    v_cvt_pk_bf16_f32 v52, v52, v53
    v_cvt_pk_bf16_f32 v53, v54, v55
    v_cvt_pk_bf16_f32 v56, v56, v57
    v_cvt_pk_bf16_f32 v57, v58, v59
    v_mfma_f32_16x16x16_bf16 v[144:147], v[48:49], v[12:13], v[144:147]
    v_mfma_f32_16x16x16_bf16 v[148:151], v[52:53], v[16:17], v[148:151]
    v_mfma_f32_16x16x16_bf16 v[152:155], v[56:57], v[20:21], v[152:155]
    v_cvt_pk_bf16_f32 v60, v60, v61
    v_cvt_pk_bf16_f32 v61, v62, v63
    v_cvt_pk_bf16_f32 v64, v64, v65
    v_cvt_pk_bf16_f32 v65, v66, v67
    v_cvt_pk_bf16_f32 v68, v68, v69
    v_cvt_pk_bf16_f32 v69, v70, v71
    v_mfma_f32_16x16x16_bf16 v[144:147], v[60:61], v[24:25], v[144:147]
    v_mfma_f32_16x16x16_bf16 v[148:151], v[64:65], v[28:29], v[148:151]
    v_mfma_f32_16x16x16_bf16 v[152:155], v[68:69], v[32:33], v[152:155]
    s_nop 5
    ds_write_b128 v236, v[144:147] offset:0
    ds_write_b128 v236, v[148:151] offset:1024
    ds_write_b128 v236, v[152:155] offset:2048
    s_waitcnt lgkmcnt(0)
    s_barrier
    ds_read_b128 v[172:175], v237 offset:0
    ds_read_b128 v[176:179], v237 offset:3072
    ds_read_b128 v[180:183], v237 offset:6144
    s_nop 0
    ds_read_b128 v[184:187], v237 offset:9216
    v_mfma_f32_16x16x32_bf16 v[72:75], a[0:3], a[72:75], 0
    s_waitcnt vmcnt(9)
    ds_read_b64_tr_b16 a[84:85], v246 offset:12288
    s_waitcnt lgkmcnt(3)
    v_add_f32 v172, v172, v176
    v_mfma_f32_16x16x32_bf16 v[84:87], a[24:27], a[72:75], 0
    ds_read_b64_tr_b16 a[86:87], v246 offset:13056
    s_waitcnt lgkmcnt(2)
    v_add_f32_e64 v180, v180, v184
    v_mfma_f32_16x16x32_bf16 v[96:99], a[48:51], a[72:75], 0
    ds_read_b64_tr_b16 a[88:89], v246 offset:12320
    v_add_f32 v173, v173, v177
    v_mfma_f32_16x16x32_bf16 v[76:79], a[0:3], a[76:79], 0
    ds_read_b64_tr_b16 a[90:91], v246 offset:13088
    v_add_f32 v181, v181, v185
    v_mfma_f32_16x16x32_bf16 v[88:91], a[24:27], a[76:79], 0
    ds_read_b64_tr_b16 a[92:93], v246 offset:12352
    v_add_f32_e64 v174, v174, v178
    v_mfma_f32_16x16x32_bf16 v[100:103], a[48:51], a[76:79], 0
    ds_read_b64_tr_b16 a[94:95], v246 offset:13120
    v_add_f32 v182, v182, v186
    v_mfma_f32_16x16x32_bf16 v[80:83], a[0:3], a[80:83], 0
    v_add_f32 v175, v175, v179
    v_add_f32 v183, v183, v187
    v_mfma_f32_16x16x32_bf16 v[92:95], a[24:27], a[80:83], 0
    v_add_f32 v172, v172, v180
    v_add_f32 v173, v173, v181
    v_mfma_f32_16x16x32_bf16 v[104:107], a[48:51], a[80:83], 0
    s_waitcnt lgkmcnt(4)
    v_add_f32 v174, v174, v182
    v_add_f32_e64 v175, v175, v183
    v_mfma_f32_16x16x32_bf16 v[72:75], a[4:7], a[84:87], v[72:75]
    s_add_u32 m0, s21, 24576
    s_waitcnt vmcnt(6)
    ds_read_b64_tr_b16 a[72:73], v246 offset:15360
    v_max3_f32 v188, v172, v173, v174
    v_mfma_f32_16x16x32_bf16 v[84:87], a[28:31], a[84:87], v[84:87]
    s_mov_b32 s28, 185088
    ds_read_b64_tr_b16 a[74:75], v246 offset:16128
    v_max_f32 v188, v188, v175
    v_mfma_f32_16x16x32_bf16 v[96:99], a[52:55], a[84:87], v[96:99]
    s_waitcnt lgkmcnt(4)
    ds_read_b64_tr_b16 a[76:77], v246 offset:15392
    buffer_load_dwordx4 v240, s[8:11], s28 offen offset:0 lds
    v_mfma_f32_16x16x32_bf16 v[76:79], a[4:7], a[88:91], v[76:79]
    ds_read_b64_tr_b16 a[78:79], v246 offset:16160
    v_mov_b32_e64 v189, v188
    v_mfma_f32_16x16x32_bf16 v[88:91], a[28:31], a[88:91], v[88:91]
    ds_read_b64_tr_b16 a[80:81], v246 offset:15424
    v_mfma_f32_16x16x32_bf16 v[100:103], a[52:55], a[88:91], v[100:103]
    s_waitcnt lgkmcnt(5)
    ds_read_b64_tr_b16 a[82:83], v246 offset:16192
    buffer_load_dwordx4 v241, s[8:11], s28 offen offset:1024 lds
    v_mfma_f32_16x16x32_bf16 v[80:83], a[4:7], a[92:95], v[80:83]
    v_permlane16_swap_b32 v188, v189
    v_mfma_f32_16x16x32_bf16 v[92:95], a[28:31], a[92:95], v[92:95]
    v_max_f32 v188, v188, v189
    v_mul_f32_e64 v188, s29, v188
    v_mfma_f32_16x16x32_bf16 v[104:107], a[52:55], a[92:95], v[104:107]
    s_waitcnt lgkmcnt(4)
    buffer_load_dwordx4 v242, s[8:11], s28 offen offset:2048 lds
    v_fma_f32 v172, v172, s29, -v188
    v_mfma_f32_16x16x32_bf16 v[72:75], a[8:11], a[72:75], v[72:75]
    s_add_u32 m0, s21, 0
    s_waitcnt vmcnt(6)
    ds_read_b64_tr_b16 a[84:85], v246 offset:18432
    v_fma_f32 v173, v173, s29, -v188
    v_mfma_f32_16x16x32_bf16 v[84:87], a[32:35], a[72:75], v[84:87]
    s_mov_b32 s35, 0
    ds_read_b64_tr_b16 a[86:87], v246 offset:19200
    v_fma_f32 v174, v174, s29, -v188
    v_mfma_f32_16x16x32_bf16 v[96:99], a[56:59], a[72:75], v[96:99]
    s_waitcnt lgkmcnt(4)
    ds_read_b64_tr_b16 a[88:89], v246 offset:18464
    buffer_load_dwordx4 v243, s[12:15], s35 offen offset:0 lds
    v_mfma_f32_16x16x32_bf16 v[76:79], a[8:11], a[76:79], v[76:79]
    ds_read_b64_tr_b16 a[90:91], v246 offset:19232
    v_fma_f32 v175, v175, s29, -v188
    v_mfma_f32_16x16x32_bf16 v[88:91], a[32:35], a[76:79], v[88:91]
    ds_read_b64_tr_b16 a[92:93], v246 offset:18496
    v_mfma_f32_16x16x32_bf16 v[100:103], a[56:59], a[76:79], v[100:103]
    s_waitcnt lgkmcnt(5)
    ds_read_b64_tr_b16 a[94:95], v246 offset:19264
    s_nop 0
    buffer_load_dwordx4 v244, s[12:15], s35 offen offset:1024 lds
    v_mfma_f32_16x16x32_bf16 v[80:83], a[8:11], a[80:83], v[80:83]
    v_exp_f32 v172, v172
    v_mfma_f32_16x16x32_bf16 v[92:95], a[32:35], a[80:83], v[92:95]
    v_exp_f32_e64 v173, v173
    v_mfma_f32_16x16x32_bf16 v[104:107], a[56:59], a[80:83], v[104:107]
    s_waitcnt lgkmcnt(4)
    buffer_load_dwordx4 v245, s[12:15], s35 offen offset:2048 lds
    v_mfma_f32_16x16x32_bf16 v[72:75], a[12:15], a[84:87], v[72:75]
    s_add_u32 m0, s21, 3072
    s_waitcnt vmcnt(6)
    ds_read_b64_tr_b16 a[72:73], v246 offset:21504
    v_mfma_f32_16x16x32_bf16 v[84:87], a[36:39], a[84:87], v[84:87]
    s_mov_b32 s28, 12288
    ds_read_b64_tr_b16 a[74:75], v246 offset:22272
    v_mfma_f32_16x16x32_bf16 v[96:99], a[60:63], a[84:87], v[96:99]
    s_waitcnt lgkmcnt(4)
    ds_read_b64_tr_b16 a[76:77], v246 offset:21536
    buffer_load_dwordx4 v243, s[12:15], s28 offen offset:0 lds
    v_mfma_f32_16x16x32_bf16 v[76:79], a[12:15], a[88:91], v[76:79]
    ds_read_b64_tr_b16 a[78:79], v246 offset:22304
    v_mfma_f32_16x16x32_bf16 v[88:91], a[36:39], a[88:91], v[88:91]
    ds_read_b64_tr_b16 a[80:81], v246 offset:21568
    v_mfma_f32_16x16x32_bf16 v[100:103], a[60:63], a[88:91], v[100:103]
    s_waitcnt lgkmcnt(5)
    ds_read_b64_tr_b16 a[82:83], v246 offset:22336
    s_nop 0
    buffer_load_dwordx4 v244, s[12:15], s28 offen offset:1024 lds
    v_mfma_f32_16x16x32_bf16 v[80:83], a[12:15], a[92:95], v[80:83]
    v_exp_f32 v174, v174
    v_mfma_f32_16x16x32_bf16 v[92:95], a[36:39], a[92:95], v[92:95]
    v_exp_f32 v175, v175
    v_mfma_f32_16x16x32_bf16 v[104:107], a[60:63], a[92:95], v[104:107]
    s_waitcnt lgkmcnt(4)
    buffer_load_dwordx4 v245, s[12:15], s28 offen offset:2048 lds
    v_add_f32 v188, v172, v173
    v_mfma_f32_16x16x32_bf16 v[72:75], a[16:19], a[72:75], v[72:75]
    s_add_u32 m0, s21, 6144
    s_waitcnt vmcnt(6)
    ds_read_b64_tr_b16 a[84:85], v246 offset:24576
    v_add_f32 v189, v174, v175
    v_mfma_f32_16x16x32_bf16 v[84:87], a[40:43], a[72:75], v[84:87]
    s_mov_b32 s35, 24576
    ds_read_b64_tr_b16 a[86:87], v246 offset:25344
    v_add_f32 v188, v188, v189
    v_mfma_f32_16x16x32_bf16 v[96:99], a[64:67], a[72:75], v[96:99]
    s_waitcnt lgkmcnt(4)
    ds_read_b64_tr_b16 a[88:89], v246 offset:24608
    buffer_load_dwordx4 v243, s[12:15], s35 offen offset:0 lds
    v_mfma_f32_16x16x32_bf16 v[76:79], a[16:19], a[76:79], v[76:79]
    ds_read_b64_tr_b16 a[90:91], v246 offset:25376
    v_mov_b32 v189, v188
    v_mfma_f32_16x16x32_bf16 v[88:91], a[40:43], a[76:79], v[88:91]
    ds_read_b64_tr_b16 a[92:93], v246 offset:24640
    v_mfma_f32_16x16x32_bf16 v[100:103], a[64:67], a[76:79], v[100:103]
    s_waitcnt lgkmcnt(5)
    ds_read_b64_tr_b16 a[94:95], v246 offset:25408
    buffer_load_dwordx4 v244, s[12:15], s35 offen offset:1024 lds
    v_mfma_f32_16x16x32_bf16 v[80:83], a[16:19], a[80:83], v[80:83]
    v_permlane16_swap_b32 v188, v189
    v_mfma_f32_16x16x32_bf16 v[92:95], a[40:43], a[80:83], v[92:95]
    v_add_f32_e64 v188, v188, v189
    v_mfma_f32_16x16x32_bf16 v[104:107], a[64:67], a[80:83], v[104:107]
    s_waitcnt lgkmcnt(4)
    buffer_load_dwordx4 v245, s[12:15], s35 offen offset:2048 lds
    v_mfma_f32_16x16x32_bf16 v[72:75], a[20:23], a[84:87], v[72:75]
    s_add_u32 m0, s21, 9216
    v_rcp_f32 v188, v188
    s_nop 0
    v_mul_f32 v172, v172, v188
    v_mul_f32 v173, v173, v188
    v_mul_f32 v174, v174, v188
    v_mul_f32 v175, v175, v188
    v_cvt_pk_bf16_f32 v190, v172, v173
    v_cvt_pk_bf16_f32 v191, v174, v175
    v_cndmask_b32 v190, 0, v190, s[40:41]
    v_cndmask_b32 v191, 0, v191, s[40:41]
    ds_write_b64 v210, v[190:191]
    s_waitcnt lgkmcnt(0)
    s_barrier
    s_waitcnt vmcnt(6)
    ds_read_b64_tr_b16 a[72:73], v247 offset:0
    v_mfma_f32_16x16x32_bf16 v[84:87], a[44:47], a[84:87], v[84:87]
    s_mov_b32 s28, 36864
    ds_read_b64_tr_b16 a[74:75], v247 offset:1536
    s_nop 0
    v_mfma_f32_16x16x32_bf16 v[96:99], a[68:71], a[84:87], v[96:99]
    ds_read_b64_tr_b16 a[76:77], v247 offset:8
    buffer_load_dwordx4 v243, s[12:15], s28 offen offset:0 lds
    v_mfma_f32_16x16x32_bf16 v[76:79], a[20:23], a[88:91], v[76:79]
    ds_read_b64_tr_b16 a[78:79], v247 offset:1544
    v_mfma_f32_16x16x32_bf16 v[88:91], a[44:47], a[88:91], v[88:91]
    ds_read_b64_tr_b16 a[80:81], v248 offset:0
    v_mfma_f32_16x16x32_bf16 v[100:103], a[68:71], a[88:91], v[100:103]
    ds_read_b64_tr_b16 a[82:83], v248 offset:1536
    buffer_load_dwordx4 v244, s[12:15], s28 offen offset:1024 lds
    v_mfma_f32_16x16x32_bf16 v[80:83], a[20:23], a[92:95], v[80:83]
    ds_read_b64 v[204:205], v211 offset:0
    v_mfma_f32_16x16x32_bf16 v[92:95], a[44:47], a[92:95], v[92:95]
    ds_read_b64 v[206:207], v211 offset:512
    v_mfma_f32_16x16x32_bf16 v[104:107], a[68:71], a[92:95], v[104:107]
    s_waitcnt lgkmcnt(6)
    s_nop 0
    ds_read_b64 v[208:209], v211 offset:1024
    buffer_load_dwordx4 v245, s[12:15], s28 offen offset:2048 lds
    v_cvt_pk_bf16_f32 v72, v72, v73
    v_cvt_pk_bf16_f32 v73, v74, v75
    v_cvt_pk_bf16_f32 v84, v84, v85
    v_cvt_pk_bf16_f32 v85, v86, v87
    s_waitcnt lgkmcnt(2)
    v_mfma_f32_16x16x16_bf16 v[0:3], v[72:73], v[204:205], 0
    s_nop 0
    v_cvt_pk_bf16_f32 v96, v96, v97
    v_cvt_pk_bf16_f32 v97, v98, v99
    s_waitcnt lgkmcnt(1)
    v_mfma_f32_16x16x16_bf16 v[12:15], v[84:85], v[206:207], 0
    v_cvt_pk_bf16_f32 v76, v76, v77
    v_cvt_pk_bf16_f32 v77, v78, v79
    s_waitcnt lgkmcnt(0)
    v_mfma_f32_16x16x16_bf16 v[24:27], v[96:97], v[208:209], 0
    v_cvt_pk_bf16_f32 v88, v88, v89
    v_cvt_pk_bf16_f32 v89, v90, v91
    v_mfma_f32_16x16x16_bf16 v[4:7], v[76:77], v[204:205], 0
    v_cvt_pk_bf16_f32 v100, v100, v101
    v_cvt_pk_bf16_f32 v101, v102, v103
    v_mfma_f32_16x16x16_bf16 v[16:19], v[88:89], v[206:207], 0
    v_cvt_pk_bf16_f32 v80, v80, v81
    v_cvt_pk_bf16_f32 v81, v82, v83
    v_mfma_f32_16x16x16_bf16 v[28:31], v[100:101], v[208:209], 0
    v_cvt_pk_bf16_f32 v92, v92, v93
    v_cvt_pk_bf16_f32 v93, v94, v95
    v_mfma_f32_16x16x16_bf16 v[8:11], v[80:81], v[204:205], 0
    v_cvt_pk_bf16_f32 v104, v104, v105
    v_cvt_pk_bf16_f32 v105, v106, v107
    v_mfma_f32_16x16x16_bf16 v[20:23], v[92:93], v[206:207], 0
    v_cvt_pk_bf16_f32 v0, v0, v1
    v_cvt_pk_bf16_f32 v1, v2, v3
    v_mfma_f32_16x16x16_bf16 v[32:35], v[104:105], v[208:209], 0
    v_cvt_pk_bf16_f32 v12, v12, v13
    v_cvt_pk_bf16_f32 v13, v14, v15
    ds_write_b64 v238, v[0:1] offset:0
    ds_write_b64 v238, v[12:13] offset:6144
    v_cvt_pk_bf16_f32 v24, v24, v25
    v_cvt_pk_bf16_f32 v25, v26, v27
    ds_write_b64 v238, v[24:25] offset:12288
    v_cvt_pk_bf16_f32 v4, v4, v5
    v_cvt_pk_bf16_f32 v5, v6, v7
    ds_write_b64 v239, v[4:5] offset:0
    v_cvt_pk_bf16_f32 v16, v16, v17
    v_cvt_pk_bf16_f32 v17, v18, v19
    ds_write_b64 v239, v[16:17] offset:6144
    v_cvt_pk_bf16_f32 v28, v28, v29
    v_cvt_pk_bf16_f32 v29, v30, v31
    ds_write_b64 v239, v[28:29] offset:12288
    v_cvt_pk_bf16_f32 v8, v8, v9
    v_cvt_pk_bf16_f32 v9, v10, v11
    ds_write_b64 v253, v[8:9] offset:0
    v_cvt_pk_bf16_f32 v20, v20, v21
    v_cvt_pk_bf16_f32 v21, v22, v23
    ds_write_b64 v253, v[20:21] offset:6144
    v_cvt_pk_bf16_f32 v32, v32, v33
    v_cvt_pk_bf16_f32 v33, v34, v35
    ds_write_b64 v253, v[32:33] offset:12288
    s_waitcnt lgkmcnt(0)
    s_barrier
    ds_read_b128 a[0:3], v235 offset:0
    ds_read_b128 a[24:27], v235 offset:6144
    ds_read_b128 a[48:51], v235 offset:12288
    s_waitcnt lgkmcnt(2)
    v_mfma_f32_16x16x32_bf16 v[108:111], a[72:75], a[0:3], v[108:111]
    s_nop 0
    s_add_u32 m0, s21, 12288
    s_waitcnt vmcnt(6)
    ds_read_b64_tr_b16 a[84:85], v247 offset:3072
    ds_read_b128 a[4:7], v235 offset:1024
    s_waitcnt lgkmcnt(3)
    v_mfma_f32_16x16x32_bf16 v[120:123], a[72:75], a[24:27], v[120:123]
    s_mov_b32 s35, 49152
    ds_read_b64_tr_b16 a[86:87], v247 offset:4608
    v_mul_u32_u24 v144, 400, v251
    s_waitcnt lgkmcnt(3)
    v_mfma_f32_16x16x32_bf16 v[132:135], a[72:75], a[48:51], v[132:135]
    ds_read_b64_tr_b16 a[88:89], v247 offset:3080
    ds_read_b128 a[28:31], v235 offset:7168
    buffer_load_dwordx4 v243, s[12:15], s35 offen offset:0 lds
    v_mfma_f32_16x16x32_bf16 v[112:115], a[76:79], a[0:3], v[112:115]
    ds_read_b64_tr_b16 a[90:91], v247 offset:4616
    v_add_u32 v144, s33, v144
    v_mfma_f32_16x16x32_bf16 v[124:127], a[76:79], a[24:27], v[124:127]
    ds_read_b64_tr_b16 a[92:93], v248 offset:3072
    ds_read_b128 a[52:55], v235 offset:13312
    v_mfma_f32_16x16x32_bf16 v[136:139], a[76:79], a[48:51], v[136:139]
    ds_read_b64_tr_b16 a[94:95], v248 offset:4608
    buffer_load_dwordx4 v244, s[12:15], s35 offen offset:1024 lds
    v_mfma_f32_16x16x32_bf16 v[116:119], a[80:83], a[0:3], v[116:119]
    v_lshl_add_u32 v212, v226, 4, v144
    v_lshl_add_u32 v213, v227, 4, v144
    v_mfma_f32_16x16x32_bf16 v[128:131], a[80:83], a[24:27], v[128:131]
    v_and_b32 v145, 1, v252
    v_lshl_add_u32 v213, v145, 3, v213
    v_mfma_f32_16x16x32_bf16 v[140:143], a[80:83], a[48:51], v[140:143]
    s_waitcnt lgkmcnt(4)
    buffer_load_dwordx4 v245, s[12:15], s35 offen offset:2048 lds
    v_lshrrev_b32 v144, 3, v250
    v_mfma_f32_16x16x32_bf16 v[108:111], a[84:87], a[4:7], v[108:111]
    s_add_u32 m0, s21, 15360
    s_waitcnt vmcnt(6)
    ds_read_b64_tr_b16 a[72:73], v247 offset:6144
    ds_read_b128 a[8:11], v235 offset:2048
    v_mfma_f32_16x16x32_bf16 v[120:123], a[84:87], a[28:31], v[120:123]
    s_mov_b32 s28, 61440
    ds_read_b64_tr_b16 a[74:75], v247 offset:7680
    v_and_b32 v145, 7, v250
    s_waitcnt lgkmcnt(4)
    v_mfma_f32_16x16x32_bf16 v[132:135], a[84:87], a[52:55], v[132:135]
    ds_read_b64_tr_b16 a[76:77], v247 offset:6152
    ds_read_b128 a[32:35], v235 offset:8192
    buffer_load_dwordx4 v243, s[12:15], s28 offen offset:0 lds
    v_mfma_f32_16x16x32_bf16 v[112:115], a[88:91], a[4:7], v[112:115]
    ds_read_b64_tr_b16 a[78:79], v247 offset:7688
    v_min_u32_e64 v146, 5, v144
    v_mfma_f32_16x16x32_bf16 v[124:127], a[88:91], a[28:31], v[124:127]
    ds_read_b64_tr_b16 a[80:81], v248 offset:6144
    ds_read_b128 a[56:59], v235 offset:14336
    v_mfma_f32_16x16x32_bf16 v[136:139], a[88:91], a[52:55], v[136:139]
    s_waitcnt lgkmcnt(8)
    ds_read_b64_tr_b16 a[82:83], v248 offset:7680
    buffer_load_dwordx4 v244, s[12:15], s28 offen offset:1024 lds
    v_mfma_f32_16x16x32_bf16 v[116:119], a[92:95], a[4:7], v[116:119]
    v_mul_u32_u24 v147, 3200, v146
    v_lshl_add_u32 v147, v145, 4, v147
    v_mfma_f32_16x16x32_bf16 v[128:131], a[92:95], a[28:31], v[128:131]
    v_add_u32 v215, s34, v147
    v_add_u32 v146, s22, v146
    v_mfma_f32_16x16x32_bf16 v[140:143], a[92:95], a[52:55], v[140:143]
    s_waitcnt lgkmcnt(4)
    buffer_load_dwordx4 v245, s[12:15], s28 offen offset:2048 lds
    v_lshrrev_b32 v147, 5, v146
    v_mfma_f32_16x16x32_bf16 v[108:111], a[72:75], a[8:11], v[108:111]
    s_waitcnt vmcnt(6)
    ds_read_b64_tr_b16 a[84:85], v247 offset:9216
    ds_read_b128 a[12:15], v235 offset:3072
    v_mfma_f32_16x16x32_bf16 v[120:123], a[72:75], a[32:35], v[120:123]
    ds_read_b64_tr_b16 a[86:87], v247 offset:10752
    v_mul_u32_u24 v147, 12288, v147
    s_waitcnt lgkmcnt(4)
    v_mfma_f32_16x16x32_bf16 v[132:135], a[72:75], a[56:59], v[132:135]
    ds_read_b64_tr_b16 a[88:89], v247 offset:9224
    ds_read_b128 a[36:39], v235 offset:9216
    v_mfma_f32_16x16x32_bf16 v[112:115], a[76:79], a[8:11], v[112:115]
    ds_read_b64_tr_b16 a[90:91], v247 offset:10760
    v_and_b32 v148, 31, v146
    v_mfma_f32_16x16x32_bf16 v[124:127], a[76:79], a[32:35], v[124:127]
    ds_read_b64_tr_b16 a[92:93], v248 offset:9216
    ds_read_b128 a[60:63], v235 offset:15360
    v_mfma_f32_16x16x32_bf16 v[136:139], a[76:79], a[56:59], v[136:139]
    s_waitcnt lgkmcnt(8)
    ds_read_b64_tr_b16 a[94:95], v248 offset:10752
    v_lshl_add_u32 v147, v148, 7, v147
    v_mfma_f32_16x16x32_bf16 v[116:119], a[80:83], a[8:11], v[116:119]
    v_and_b32 v148, 6, v146
    v_xor_b32 v148, v148, v145
    v_mfma_f32_16x16x32_bf16 v[128:131], a[80:83], a[32:35], v[128:131]
    v_lshl_add_u32 v216, v148, 4, v147
    v_lshlrev_b32_e64 v214, 3, v146
    v_mfma_f32_16x16x32_bf16 v[140:143], a[80:83], a[56:59], v[140:143]
    s_waitcnt lgkmcnt(4)
    v_mov_b32 v146, 0x7ffffff0
    v_cmp_lt_u32 vcc, 5, v144
    v_mfma_f32_16x16x32_bf16 v[108:111], a[84:87], a[12:15], v[108:111]
    s_waitcnt vmcnt(3)
    ds_read_b64_tr_b16 a[72:73], v247 offset:12288
    ds_read_b128 a[16:19], v235 offset:4096
    v_mfma_f32_16x16x32_bf16 v[120:123], a[84:87], a[36:39], v[120:123]
    ds_read_b64_tr_b16 a[74:75], v247 offset:13824
    v_cndmask_b32 v216, v216, v146, vcc
    s_waitcnt lgkmcnt(4)
    v_mfma_f32_16x16x32_bf16 v[132:135], a[84:87], a[60:63], v[132:135]
    ds_read_b64_tr_b16 a[76:77], v247 offset:12296
    ds_read_b128 a[40:43], v235 offset:10240
    v_mfma_f32_16x16x32_bf16 v[112:115], a[88:91], a[12:15], v[112:115]
    ds_read_b64_tr_b16 a[78:79], v247 offset:13832
    v_cndmask_b32 v214, v214, v146, vcc
    v_mfma_f32_16x16x32_bf16 v[124:127], a[88:91], a[36:39], v[124:127]
    ds_read_b64_tr_b16 a[80:81], v248 offset:12288
    ds_read_b128 a[64:67], v235 offset:16384
    v_mfma_f32_16x16x32_bf16 v[136:139], a[88:91], a[60:63], v[136:139]
    s_waitcnt lgkmcnt(8)
    ds_read_b64_tr_b16 a[82:83], v248 offset:13824
    v_cmp_ne_u32 vcc, 0, v145
    v_mfma_f32_16x16x32_bf16 v[116:119], a[92:95], a[12:15], v[116:119]
    s_nop 0
    v_cndmask_b32 v214, v214, v146, vcc
    v_mfma_f32_16x16x32_bf16 v[128:131], a[92:95], a[36:39], v[128:131]
    v_mfma_f32_16x16x32_bf16 v[140:143], a[92:95], a[60:63], v[140:143]
    s_waitcnt lgkmcnt(4)
    v_mfma_f32_16x16x32_bf16 v[108:111], a[72:75], a[16:19], v[108:111]
    s_waitcnt vmcnt(0)
    ds_read_b64_tr_b16 a[84:85], v247 offset:15360
    s_nop 0
    ds_read_b128 a[20:23], v235 offset:5120
    v_mfma_f32_16x16x32_bf16 v[120:123], a[72:75], a[40:43], v[120:123]
    ds_read_b64_tr_b16 a[86:87], v247 offset:16896
    s_waitcnt lgkmcnt(4)
    v_mfma_f32_16x16x32_bf16 v[132:135], a[72:75], a[64:67], v[132:135]
    ds_read_b64_tr_b16 a[88:89], v247 offset:15368
    ds_read_b128 a[44:47], v235 offset:11264
    v_mfma_f32_16x16x32_bf16 v[112:115], a[76:79], a[16:19], v[112:115]
    s_nop 0
    ds_read_b64_tr_b16 a[90:91], v247 offset:16904
    v_mfma_f32_16x16x32_bf16 v[124:127], a[76:79], a[40:43], v[124:127]
    ds_read_b64_tr_b16 a[92:93], v248 offset:15360
    ds_read_b128 a[68:71], v235 offset:17408
    v_mfma_f32_16x16x32_bf16 v[136:139], a[76:79], a[64:67], v[136:139]
    s_waitcnt lgkmcnt(8)
    ds_read_b64_tr_b16 a[94:95], v248 offset:16896
    v_mfma_f32_16x16x32_bf16 v[116:119], a[80:83], a[16:19], v[116:119]
    s_nop 0
    v_mfma_f32_16x16x32_bf16 v[128:131], a[80:83], a[40:43], v[128:131]
    v_mfma_f32_16x16x32_bf16 v[140:143], a[80:83], a[64:67], v[140:143]
    s_waitcnt lgkmcnt(4)
    v_mfma_f32_16x16x32_bf16 v[108:111], a[84:87], a[20:23], v[108:111]
    v_mfma_f32_16x16x32_bf16 v[120:123], a[84:87], a[44:47], v[120:123]
    s_waitcnt lgkmcnt(1)
    v_mfma_f32_16x16x32_bf16 v[132:135], a[84:87], a[68:71], v[132:135]
    v_mfma_f32_16x16x32_bf16 v[112:115], a[88:91], a[20:23], v[112:115]
    v_mfma_f32_16x16x32_bf16 v[124:127], a[88:91], a[44:47], v[124:127]
    v_mfma_f32_16x16x32_bf16 v[136:139], a[88:91], a[68:71], v[136:139]
    s_waitcnt lgkmcnt(0)
    v_mfma_f32_16x16x32_bf16 v[116:119], a[92:95], a[20:23], v[116:119]
    v_mfma_f32_16x16x32_bf16 v[128:131], a[92:95], a[44:47], v[128:131]
    v_mfma_f32_16x16x32_bf16 v[140:143], a[92:95], a[68:71], v[140:143]
    v_cvt_pk_bf16_f32 v108, v108, v109
    v_cvt_pk_bf16_f32 v109, v110, v111
    v_cvt_pk_bf16_f32 v110, v112, v113
    s_nop 0
    v_cvt_pk_bf16_f32 v111, v114, v115
    s_nop 1
    v_cvt_pk_bf16_f32 v112, v116, v117
    v_cvt_pk_bf16_f32 v113, v118, v119
    ds_write_b128 v212, v[108:111] offset:0
    ds_write_b64 v213, v[112:113] offset:0
    v_cvt_pk_bf16_f32 v120, v120, v121
    v_cvt_pk_bf16_f32 v121, v122, v123
    s_nop 0
    v_cvt_pk_bf16_f32 v122, v124, v125
    v_cvt_pk_bf16_f32 v123, v126, v127
    v_cvt_pk_bf16_f32 v124, v128, v129
    v_cvt_pk_bf16_f32 v125, v130, v131
    ds_write_b128 v212, v[120:123] offset:6400
    ds_write_b64 v213, v[124:125] offset:6400
    v_cvt_pk_bf16_f32 v132, v132, v133
    v_cvt_pk_bf16_f32 v133, v134, v135
    v_cvt_pk_bf16_f32 v134, v136, v137
    v_cvt_pk_bf16_f32 v135, v138, v139
    v_cvt_pk_bf16_f32 v136, v140, v141
    v_cvt_pk_bf16_f32 v137, v142, v143
    ds_write_b128 v212, v[132:135] offset:12800
    ds_write_b64 v213, v[136:137] offset:12800
    v_mov_b32 v60, 0x3f803f80
    v_mov_b32 v48, 0
    v_mov_b32 v24, 0
    v_mov_b32 v49, 0
    v_mov_b32 v25, 0
    v_mov_b32 v50, 0
    v_mov_b32 v26, 0
    v_mov_b32 v51, 0
    v_mov_b32 v27, 0
    s_waitcnt lgkmcnt(0)
    s_barrier
    ds_read_b128 v[0:3], v215 offset:0
    ds_read_b128 v[4:7], v215 offset:128
    ds_read_b128 v[8:11], v215 offset:256
    ds_read_b128 v[12:15], v215 offset:400
    ds_read_b128 v[16:19], v215 offset:528
    ds_read_b128 v[20:23], v215 offset:656
    s_waitcnt lgkmcnt(5)
    v_dot2c_f32_bf16 v48, v0, v60
    v_dot2c_f32_bf16 v50, v0, v0
    s_waitcnt lgkmcnt(2)
    v_dot2c_f32_bf16 v49, v12, v60
    v_dot2c_f32_bf16 v51, v12, v12
    v_dot2c_f32_bf16 v24, v1, v60
    v_dot2c_f32_bf16 v26, v1, v1
    v_dot2c_f32_bf16 v25, v13, v60
    v_dot2c_f32_bf16 v27, v13, v13
    v_dot2c_f32_bf16 v48, v2, v60
    v_dot2c_f32_bf16 v50, v2, v2
    v_dot2c_f32_bf16 v49, v14, v60
    v_dot2c_f32_bf16 v51, v14, v14
    v_dot2c_f32_bf16 v24, v3, v60
    v_dot2c_f32_bf16 v26, v3, v3
    v_dot2c_f32_bf16 v25, v15, v60
    v_dot2c_f32_bf16 v27, v15, v15
    v_dot2c_f32_bf16 v48, v4, v60
    v_dot2c_f32_bf16 v50, v4, v4
    s_waitcnt lgkmcnt(1)
    v_dot2c_f32_bf16 v49, v16, v60
    v_dot2c_f32_bf16 v51, v16, v16
    v_dot2c_f32_bf16 v24, v5, v60
    v_dot2c_f32_bf16 v26, v5, v5
    v_dot2c_f32_bf16 v25, v17, v60
    v_dot2c_f32_bf16 v27, v17, v17
    v_dot2c_f32_bf16 v48, v6, v60
    v_dot2c_f32_bf16 v50, v6, v6
    v_dot2c_f32_bf16 v49, v18, v60
    v_dot2c_f32_bf16 v51, v18, v18
    v_dot2c_f32_bf16 v24, v7, v60
    v_dot2c_f32_bf16 v26, v7, v7
    v_dot2c_f32_bf16 v25, v19, v60
    v_dot2c_f32_bf16 v27, v19, v19
    v_dot2c_f32_bf16 v48, v8, v60
    v_dot2c_f32_bf16 v50, v8, v8
    s_waitcnt lgkmcnt(0)
    v_dot2c_f32_bf16 v49, v20, v60
    v_dot2c_f32_bf16 v51, v20, v20
    v_dot2c_f32_bf16 v24, v9, v60
    v_dot2c_f32_bf16 v26, v9, v9
    v_dot2c_f32_bf16 v25, v21, v60
    v_dot2c_f32_bf16 v27, v21, v21
    v_dot2c_f32_bf16 v48, v10, v60
    v_dot2c_f32_bf16 v50, v10, v10
    v_dot2c_f32_bf16 v49, v22, v60
    v_dot2c_f32_bf16 v51, v22, v22
    v_dot2c_f32_bf16 v24, v11, v60
    v_dot2c_f32_bf16 v26, v11, v11
    v_dot2c_f32_bf16 v25, v23, v60
    v_dot2c_f32_bf16 v27, v23, v23
    v_add_f32 v48, v48, v24
    s_nop 0
    v_add_f32 v49, v49, v25
    v_add_f32 v50, v50, v26
    v_add_f32_e64 v51, v51, v27
    v_add_f32_dpp v48, v48, v48 quad_perm:[1,0,3,2] row_mask:0xf bank_mask:0xf
    v_add_f32_dpp v49, v49, v49 quad_perm:[1,0,3,2] row_mask:0xf bank_mask:0xf
    v_add_f32_dpp v50, v50, v50 quad_perm:[1,0,3,2] row_mask:0xf bank_mask:0xf
    v_add_f32_dpp v51, v51, v51 quad_perm:[1,0,3,2] row_mask:0xf bank_mask:0xf
    v_lshlrev_b32_e64 v64, 16, v0
    v_and_b32 v65, 0xffff0000, v0
    v_add_f32_dpp v48, v48, v48 quad_perm:[2,3,0,1] row_mask:0xf bank_mask:0xf
    v_add_f32_dpp v49, v49, v49 quad_perm:[2,3,0,1] row_mask:0xf bank_mask:0xf
    v_add_f32_dpp v50, v50, v50 quad_perm:[2,3,0,1] row_mask:0xf bank_mask:0xf
    v_add_f32_dpp v51, v51, v51 quad_perm:[2,3,0,1] row_mask:0xf bank_mask:0xf
    v_lshlrev_b32 v66, 16, v1
    v_and_b32 v67, 0xffff0000, v1
    v_add_f32_dpp v48, v48, v48 row_half_mirror row_mask:0xf bank_mask:0xf
    v_add_f32_dpp v49, v49, v49 row_half_mirror row_mask:0xf bank_mask:0xf
    v_add_f32_dpp v50, v50, v50 row_half_mirror row_mask:0xf bank_mask:0xf
    v_add_f32_dpp v51, v51, v51 row_half_mirror row_mask:0xf bank_mask:0xf
    v_lshlrev_b32 v68, 16, v2
    v_and_b32 v69, 0xffff0000, v2
    v_mul_f32 v52, 0x3baaaaab, v48
    v_mul_f32 v56, 0x3baaaaab, v49
    v_mul_f32 v48, v52, v52
    v_mul_f32 v49, v56, v56
    v_fma_f32 v50, v50, s36, -v48
    v_fma_f32 v51, v51, s36, -v49
    v_max_f32 v50, 0, v50
    v_max_f32 v51, 0, v51
    v_add_f32 v50, 0x3727c5ac, v50
    v_add_f32 v51, 0x3727c5ac, v51
    v_rsq_f32 v54, v50
    v_rsq_f32 v58, v51
    v_lshlrev_b32 v70, 16, v3
    v_and_b32 v71, 0xffff0000, v3
    v_lshlrev_b32 v72, 16, v4
    v_and_b32 v73, 0xffff0000, v4
    v_mul_f32 v53, v50, v54
    v_mul_f32 v57, v51, v58
    v_mul_f32 v60, v52, v54
    v_mul_f32 v62, v56, v58
    v_sub_f32 v60, 0, v60
    v_sub_f32 v62, 0, v62
    v_lshlrev_b32_e64 v74, 16, v5
    v_and_b32 v75, 0xffff0000, v5
    v_lshlrev_b32 v76, 16, v6
    v_and_b32 v77, 0xffff0000, v6
    v_lshlrev_b32 v78, 16, v7
    v_and_b32 v79, 0xffff0000, v7
    v_lshlrev_b32 v80, 16, v8
    v_and_b32 v81, 0xffff0000, v8
    v_lshlrev_b32 v82, 16, v9
    v_and_b32 v83, 0xffff0000, v9
    v_lshlrev_b32_e64 v84, 16, v10
    v_and_b32 v85, 0xffff0000, v10
    v_lshlrev_b32 v86, 16, v11
    v_and_b32 v87, 0xffff0000, v11
    v_lshlrev_b32 v88, 16, v12
    v_and_b32 v89, 0xffff0000, v12
    v_pk_fma_f32 v[64:65], v[64:65], v[54:55], v[60:61] op_sel_hi:[1,0,0]
    v_cvt_pk_bf16_f32 v0, v64, v65
    v_lshlrev_b32_e64 v90, 16, v13
    v_and_b32 v91, 0xffff0000, v13
    v_pk_fma_f32 v[66:67], v[66:67], v[54:55], v[60:61] op_sel_hi:[1,0,0]
    v_cvt_pk_bf16_f32 v1, v66, v67
    v_lshlrev_b32 v92, 16, v14
    v_and_b32 v93, 0xffff0000, v14
    v_pk_fma_f32 v[68:69], v[68:69], v[54:55], v[60:61] op_sel_hi:[1,0,0]
    v_cvt_pk_bf16_f32 v2, v68, v69
    v_lshlrev_b32 v94, 16, v15
    v_and_b32 v95, 0xffff0000, v15
    v_pk_fma_f32 v[70:71], v[70:71], v[54:55], v[60:61] op_sel_hi:[1,0,0]
    v_cvt_pk_bf16_f32 v3, v70, v71
    buffer_store_dwordx4 v[0:3], v216, s[16:19], s42 offen
    v_lshlrev_b32 v96, 16, v16
    v_and_b32 v97, 0xffff0000, v16
    v_pk_fma_f32 v[72:73], v[72:73], v[54:55], v[60:61] op_sel_hi:[1,0,0]
    v_cvt_pk_bf16_f32 v4, v72, v73
    v_lshlrev_b32 v98, 16, v17
    v_and_b32 v99, 0xffff0000, v17
    v_pk_fma_f32 v[74:75], v[74:75], v[54:55], v[60:61] op_sel_hi:[1,0,0]
    v_cvt_pk_bf16_f32 v5, v74, v75
    v_lshlrev_b32 v100, 16, v18
    v_and_b32 v101, 0xffff0000, v18
    v_pk_fma_f32 v[76:77], v[76:77], v[54:55], v[60:61] op_sel_hi:[1,0,0]
    v_cvt_pk_bf16_f32 v6, v76, v77
    v_lshlrev_b32 v102, 16, v19
    v_and_b32 v103, 0xffff0000, v19
    v_pk_fma_f32 v[78:79], v[78:79], v[54:55], v[60:61] op_sel_hi:[1,0,0]
    v_cvt_pk_bf16_f32 v7, v78, v79
    buffer_store_dwordx4 v[4:7], v216, s[16:19], s43 offen
    v_lshlrev_b32 v104, 16, v20
    v_and_b32 v105, 0xffff0000, v20
    v_pk_fma_f32 v[80:81], v[80:81], v[54:55], v[60:61] op_sel_hi:[1,0,0]
    v_cvt_pk_bf16_f32 v8, v80, v81
    v_lshlrev_b32 v106, 16, v21
    v_and_b32 v107, 0xffff0000, v21
    v_pk_fma_f32 v[82:83], v[82:83], v[54:55], v[60:61] op_sel_hi:[1,0,0]
    v_cvt_pk_bf16_f32 v9, v82, v83
    v_lshlrev_b32 v108, 16, v22
    v_and_b32 v109, 0xffff0000, v22
    v_pk_fma_f32 v[84:85], v[84:85], v[54:55], v[60:61] op_sel_hi:[1,0,0]
    v_cvt_pk_bf16_f32 v10, v84, v85
    v_lshlrev_b32 v110, 16, v23
    v_and_b32 v111, 0xffff0000, v23
    v_pk_fma_f32 v[86:87], v[86:87], v[54:55], v[60:61] op_sel_hi:[1,0,0]
    v_cvt_pk_bf16_f32 v11, v86, v87
    buffer_store_dwordx4 v[8:11], v216, s[16:19], s44 offen
    buffer_store_dwordx2 v[52:53], v214, s[16:19], s31 offen
    v_pk_fma_f32 v[88:89], v[88:89], v[58:59], v[62:63] op_sel_hi:[1,0,0]
    v_cvt_pk_bf16_f32 v12, v88, v89
    v_pk_fma_f32 v[90:91], v[90:91], v[58:59], v[62:63] op_sel_hi:[1,0,0]
    v_cvt_pk_bf16_f32 v13, v90, v91
    v_pk_fma_f32 v[92:93], v[92:93], v[58:59], v[62:63] op_sel_hi:[1,0,0]
    v_cvt_pk_bf16_f32 v14, v92, v93
    v_pk_fma_f32 v[94:95], v[94:95], v[58:59], v[62:63] op_sel_hi:[1,0,0]
    v_cvt_pk_bf16_f32 v15, v94, v95
    buffer_store_dwordx4 v[12:15], v216, s[16:19], s45 offen
    v_pk_fma_f32 v[96:97], v[96:97], v[58:59], v[62:63] op_sel_hi:[1,0,0]
    v_cvt_pk_bf16_f32 v16, v96, v97
    v_pk_fma_f32 v[98:99], v[98:99], v[58:59], v[62:63] op_sel_hi:[1,0,0]
    v_cvt_pk_bf16_f32 v17, v98, v99
    v_pk_fma_f32 v[100:101], v[100:101], v[58:59], v[62:63] op_sel_hi:[1,0,0]
    v_cvt_pk_bf16_f32 v18, v100, v101
    v_pk_fma_f32 v[102:103], v[102:103], v[58:59], v[62:63] op_sel_hi:[1,0,0]
    v_cvt_pk_bf16_f32 v19, v102, v103
    buffer_store_dwordx4 v[16:19], v216, s[16:19], s46 offen
    v_pk_fma_f32 v[104:105], v[104:105], v[58:59], v[62:63] op_sel_hi:[1,0,0]
    v_cvt_pk_bf16_f32 v20, v104, v105
    v_pk_fma_f32 v[106:107], v[106:107], v[58:59], v[62:63] op_sel_hi:[1,0,0]
    v_cvt_pk_bf16_f32 v21, v106, v107
    v_pk_fma_f32 v[108:109], v[108:109], v[58:59], v[62:63] op_sel_hi:[1,0,0]
    v_cvt_pk_bf16_f32 v22, v108, v109
    v_pk_fma_f32 v[110:111], v[110:111], v[58:59], v[62:63] op_sel_hi:[1,0,0]
    v_cvt_pk_bf16_f32 v23, v110, v111
    buffer_store_dwordx4 v[20:23], v216, s[16:19], s47 offen
    buffer_store_dwordx2 v[56:57], v214, s[16:19], s32 offen
    s_endpgm
K1_SIDE:
    s_load_dwordx2 s[8:9], s[0:1], 24
    s_load_dwordx2 s[12:13], s[0:1], 32
    s_nop 0
    s_load_dwordx2 s[16:17], s[0:1], 56
    v_lshrrev_b32 v230, 6, v0
    v_and_b32 v250, 63, v0
    v_readfirstlane_b32 s20, v230
    v_and_b32 v251, 15, v250
    v_lshrrev_b32_e64 v252, 4, v250
    s_getpc_b64 s[88:89]
K1_PC2:
    s_add_u32 s88, s88, k2_kernel-K1_PC2
    s_addc_u32 s89, s89, 0
    s_and_b32 s89, s89, 0xffff
    s_mov_b32 s90, K2_CODE_END-k2_kernel
    s_mov_b32 s91, 0x20000
    s_sub_u32 s24, s2, 216
    s_lshr_b32 s24, s24, 3
    s_lshl_b32 s24, s24, 2
    s_add_u32 s24, s24, s20
    s_mul_i32 s24, s24, 12
    v_min_u32 v231, 11, v250
    v_add_u32 v231, s24, v231
    v_lshlrev_b32 v231, 7, v231
    buffer_load_dword a255, v231, s[88:91], 0 offen
    s_sub_u32 s24, s2, 216
    s_and_b32 s26, s24, 7
    s_lshr_b32 s24, s24, 3
    s_lshl_b32 s24, s24, 2
    s_add_u32 s24, s24, s20
    s_cmp_ge_u32 s24, 18
    s_cbranch_scc1 K1_EXIT
    s_lshr_b32 s25, s26, 2
    s_mul_i32 s27, s24, 10923
    s_lshr_b32 s27, s27, 16
    s_mul_i32 s28, s27, 6
    s_sub_u32 s29, s24, s28
    s_and_b32 s28, s26, 1
    s_mul_i32 s28, s28, 3
    s_add_u32 s28, s28, s27
    s_lshr_b32 s27, s26, 1
    s_and_b32 s27, s27, 1
    s_mul_i32 s27, s27, 6
    s_add_u32 s27, s27, s29
    s_mul_i32 s26, s27, 21846
    s_lshr_b32 s26, s26, 16
    s_mul_i32 s29, s26, 3
    s_sub_u32 s29, s27, s29
    s_mul_i32 s24, s26, 18
    s_mul_i32 s27, s28, 3
    s_add_u32 s24, s24, s27
    s_add_u32 s24, s24, s29
    s_waitcnt lgkmcnt(0)
    s_and_b32 s9, s9, 0xffff
    s_mov_b32 s10, 221184
    s_mov_b32 s11, 0x20000
    s_and_b32 s13, s13, 0xffff
    s_mov_b32 s14, 73728
    s_mov_b32 s15, 0x20000
    s_and_b32 s17, s17, 0xffff
    s_mov_b32 s18, 4587520
    s_mov_b32 s19, 0x20000
    s_lshl_b32 s30, s24, 10
    v_lshlrev_b32 v249, 4, v250
    s_cmp_eq_u32 s25, 1
    s_cbranch_scc1 K1_SIDE_VO
    s_add_u32 s30, s30, 4325376
    v_lshrrev_b32 v230, 2, v251
    v_and_b32 v231, 3, v251
    v_lshl_add_u32 v230, v230, 3, v231
    s_lshl_b32 s31, s28, 5
    v_add_u32 v232, s31, v230
    v_mul_u32_u24 v232, 1152, v232
    v_lshl_add_u32 v232, v252, 4, v232
    v_add_u32 v233, 4608, v232
    s_mul_i32 s31, s26, 3
    s_add_u32 s31, s31, s29
    s_lshr_b32 s32, s31, 1
    s_lshl_b32 s32, s32, 5
    s_and_b32 s31, s31, 1
    s_lshl_b32 s31, s31, 2
    s_add_u32 s31, s31, s32
    v_add_u32 v230, s31, v230
    v_mul_u32_u24 v230, 1152, v230
    v_lshl_add_u32 v230, v252, 4, v230
    buffer_load_dwordx4 v[0:3], v232, s[8:11], 0 offen offset:0
    buffer_load_dwordx4 v[24:27], v233, s[8:11], 0 offen offset:0
    buffer_load_dwordx4 v[48:51], v230, s[8:11], 0 offen offset:384
    buffer_load_dwordx4 v[4:7], v232, s[8:11], 0 offen offset:64
    buffer_load_dwordx4 v[28:31], v233, s[8:11], 0 offen offset:64
    buffer_load_dwordx4 v[52:55], v230, s[8:11], 0 offen offset:448
    buffer_load_dwordx4 v[8:11], v232, s[8:11], 0 offen offset:128
    buffer_load_dwordx4 v[32:35], v233, s[8:11], 0 offen offset:128
    buffer_load_dwordx4 v[56:59], v230, s[8:11], 0 offen offset:512
    buffer_load_dwordx4 v[12:15], v232, s[8:11], 0 offen offset:192
    buffer_load_dwordx4 v[36:39], v233, s[8:11], 0 offen offset:192
    buffer_load_dwordx4 v[60:63], v230, s[8:11], 0 offen offset:576
    buffer_load_dwordx4 v[16:19], v232, s[8:11], 0 offen offset:256
    buffer_load_dwordx4 v[40:43], v233, s[8:11], 0 offen offset:256
    buffer_load_dwordx4 v[64:67], v230, s[8:11], 0 offen offset:640
    buffer_load_dwordx4 v[20:23], v232, s[8:11], 0 offen offset:320
    buffer_load_dwordx4 v[44:47], v233, s[8:11], 0 offen offset:320
    buffer_load_dwordx4 v[68:71], v230, s[8:11], 0 offen offset:704
    s_waitcnt vmcnt(15)
    v_mfma_f32_16x16x32_bf16 v[72:75], v[0:3], v[48:51], 0
    v_mfma_f32_16x16x32_bf16 v[76:79], v[24:27], v[48:51], 0
    s_waitcnt vmcnt(12)
    v_mfma_f32_16x16x32_bf16 v[72:75], v[4:7], v[52:55], v[72:75]
    v_mfma_f32_16x16x32_bf16 v[76:79], v[28:31], v[52:55], v[76:79]
    s_waitcnt vmcnt(9)
    v_mfma_f32_16x16x32_bf16 v[72:75], v[8:11], v[56:59], v[72:75]
    v_mfma_f32_16x16x32_bf16 v[76:79], v[32:35], v[56:59], v[76:79]
    s_waitcnt vmcnt(6)
    v_mfma_f32_16x16x32_bf16 v[72:75], v[12:15], v[60:63], v[72:75]
    v_mfma_f32_16x16x32_bf16 v[76:79], v[36:39], v[60:63], v[76:79]
    s_waitcnt vmcnt(3)
    v_mfma_f32_16x16x32_bf16 v[72:75], v[16:19], v[64:67], v[72:75]
    v_mfma_f32_16x16x32_bf16 v[76:79], v[40:43], v[64:67], v[76:79]
    s_waitcnt vmcnt(0)
    v_mfma_f32_16x16x32_bf16 v[72:75], v[20:23], v[68:71], v[72:75]
    v_mfma_f32_16x16x32_bf16 v[76:79], v[44:47], v[68:71], v[76:79]
    s_nop 6
    s_nop 0
    v_mul_f32 v72, 0x3dd53b95, v72
    v_mul_f32 v73, 0x3dd53b95, v73
    v_mul_f32 v74, 0x3dd53b95, v74
    v_mul_f32 v75, 0x3dd53b95, v75
    v_mul_f32 v76, 0x3dd53b95, v76
    v_mul_f32 v77, 0x3dd53b95, v77
    v_mul_f32 v78, 0x3dd53b95, v78
    v_mul_f32 v79, 0x3dd53b95, v79
    v_cvt_pk_bf16_f32 v72, v72, v73
    v_cvt_pk_bf16_f32 v73, v74, v75
    v_cvt_pk_bf16_f32 v74, v76, v77
    v_cvt_pk_bf16_f32 v75, v78, v79
    buffer_store_dwordx4 v[72:75], v249, s[16:19], s30 offen
    s_endpgm
K1_SIDE_VO:
    s_add_u32 s30, s30, 4456448
    s_lshl_b32 s31, s28, 5
    v_add_u32_e64 v232, s31, v251
    v_mul_u32_u24 v232, 1152, v232
    v_lshl_add_u32 v232, v252, 4, v232
    v_add_u32 v233, 18432, v232
    v_lshrrev_b32 v230, 2, v251
    v_and_b32 v231, 3, v251
    s_cmp_eq_u32 s29, 2
    s_cselect_b32 s31, 2, 3
    s_cselect_b32 s32, 32, 0
    s_lshl_b32 s33, s29, 2
    s_cselect_b32 s33, s33, s33
    s_cmp_eq_u32 s29, 2
    s_cselect_b32 s33, 0, s33
    s_add_u32 s32, s32, s33
    s_mul_i32 s33, s26, 48
    s_add_u32 s32, s32, s33
    v_lshlrev_b32 v230, s31, v230
    v_add_u32 v230, v230, v231
    v_add_u32 v230, s32, v230
    v_lshlrev_b32 v230, 1, v230
    v_mul_u32_u24 v231, 3072, v252
    v_add_u32_e64 v230, v230, v231
    buffer_load_dwordx4 v[0:3], v232, s[8:11], 0 offen offset:768
    buffer_load_dwordx4 v[24:27], v233, s[8:11], 0 offen offset:768
    buffer_load_dwordx4 v[4:7], v232, s[8:11], 0 offen offset:832
    buffer_load_dwordx4 v[28:31], v233, s[8:11], 0 offen offset:832
    buffer_load_dwordx4 v[8:11], v232, s[8:11], 0 offen offset:896
    buffer_load_dwordx4 v[32:35], v233, s[8:11], 0 offen offset:896
    buffer_load_dwordx4 v[12:15], v232, s[8:11], 0 offen offset:960
    buffer_load_dwordx4 v[36:39], v233, s[8:11], 0 offen offset:960
    buffer_load_dwordx4 v[16:19], v232, s[8:11], 0 offen offset:1024
    buffer_load_dwordx4 v[40:43], v233, s[8:11], 0 offen offset:1024
    buffer_load_dwordx4 v[20:23], v232, s[8:11], 0 offen offset:1088
    buffer_load_dwordx4 v[44:47], v233, s[8:11], 0 offen offset:1088
    s_mov_b32 s31, 0
    buffer_load_ushort v80, v230, s[12:15], s31 offen offset:0
    buffer_load_ushort v81, v230, s[12:15], s31 offen offset:384
    buffer_load_ushort v82, v230, s[12:15], s31 offen offset:768
    buffer_load_ushort v83, v230, s[12:15], s31 offen offset:1152
    buffer_load_ushort v84, v230, s[12:15], s31 offen offset:1536
    buffer_load_ushort v85, v230, s[12:15], s31 offen offset:1920
    s_nop 0
    buffer_load_ushort v86, v230, s[12:15], s31 offen offset:2304
    buffer_load_ushort v87, v230, s[12:15], s31 offen offset:2688
    s_mov_b32 s31, 12288
    buffer_load_ushort v88, v230, s[12:15], s31 offen offset:0
    buffer_load_ushort v89, v230, s[12:15], s31 offen offset:384
    buffer_load_ushort v90, v230, s[12:15], s31 offen offset:768
    buffer_load_ushort v91, v230, s[12:15], s31 offen offset:1152
    buffer_load_ushort v92, v230, s[12:15], s31 offen offset:1536
    buffer_load_ushort v93, v230, s[12:15], s31 offen offset:1920
    buffer_load_ushort v94, v230, s[12:15], s31 offen offset:2304
    buffer_load_ushort v95, v230, s[12:15], s31 offen offset:2688
    s_mov_b32 s31, 24576
    buffer_load_ushort v96, v230, s[12:15], s31 offen offset:0
    buffer_load_ushort v97, v230, s[12:15], s31 offen offset:384
    buffer_load_ushort v98, v230, s[12:15], s31 offen offset:768
    buffer_load_ushort v99, v230, s[12:15], s31 offen offset:1152
    buffer_load_ushort v100, v230, s[12:15], s31 offen offset:1536
    buffer_load_ushort v101, v230, s[12:15], s31 offen offset:1920
    buffer_load_ushort v102, v230, s[12:15], s31 offen offset:2304
    buffer_load_ushort v103, v230, s[12:15], s31 offen offset:2688
    s_mov_b32 s31, 36864
    buffer_load_ushort v104, v230, s[12:15], s31 offen offset:0
    buffer_load_ushort v105, v230, s[12:15], s31 offen offset:384
    buffer_load_ushort v106, v230, s[12:15], s31 offen offset:768
    buffer_load_ushort v107, v230, s[12:15], s31 offen offset:1152
    buffer_load_ushort v108, v230, s[12:15], s31 offen offset:1536
    buffer_load_ushort v109, v230, s[12:15], s31 offen offset:1920
    buffer_load_ushort v110, v230, s[12:15], s31 offen offset:2304
    buffer_load_ushort v111, v230, s[12:15], s31 offen offset:2688
    s_waitcnt vmcnt(20)
    s_mov_b32 s31, 49152
    buffer_load_ushort v112, v230, s[12:15], s31 offen offset:0
    s_nop 0
    buffer_load_ushort v113, v230, s[12:15], s31 offen offset:384
    buffer_load_ushort v114, v230, s[12:15], s31 offen offset:768
    buffer_load_ushort v115, v230, s[12:15], s31 offen offset:1152
    buffer_load_ushort v116, v230, s[12:15], s31 offen offset:1536
    buffer_load_ushort v117, v230, s[12:15], s31 offen offset:1920
    buffer_load_ushort v118, v230, s[12:15], s31 offen offset:2304
    buffer_load_ushort v119, v230, s[12:15], s31 offen offset:2688
    s_mov_b32 s31, 61440
    buffer_load_ushort v120, v230, s[12:15], s31 offen offset:0
    buffer_load_ushort v121, v230, s[12:15], s31 offen offset:384
    buffer_load_ushort v122, v230, s[12:15], s31 offen offset:768
    buffer_load_ushort v123, v230, s[12:15], s31 offen offset:1152
    buffer_load_ushort v124, v230, s[12:15], s31 offen offset:1536
    buffer_load_ushort v125, v230, s[12:15], s31 offen offset:1920
    buffer_load_ushort v126, v230, s[12:15], s31 offen offset:2304
    buffer_load_ushort v127, v230, s[12:15], s31 offen offset:2688
    v_lshl_or_b32 v48, v81, 16, v80
    v_lshl_or_b32 v49, v83, 16, v82
    v_lshl_or_b32 v50, v85, 16, v84
    v_lshl_or_b32 v51, v87, 16, v86
    s_nop 1
    v_mfma_f32_16x16x32_bf16 v[72:75], v[0:3], v[48:51], 0
    v_mfma_f32_16x16x32_bf16 v[76:79], v[24:27], v[48:51], 0
    v_lshl_or_b32 v52, v89, 16, v88
    s_nop 0
    v_lshl_or_b32 v53, v91, 16, v90
    s_waitcnt vmcnt(34)
    v_lshl_or_b32 v54, v93, 16, v92
    s_waitcnt vmcnt(32)
    v_lshl_or_b32 v55, v95, 16, v94
    s_nop 1
    v_mfma_f32_16x16x32_bf16 v[72:75], v[4:7], v[52:55], v[72:75]
    v_mfma_f32_16x16x32_bf16 v[76:79], v[28:31], v[52:55], v[76:79]
    s_waitcnt vmcnt(30)
    v_lshl_or_b32 v56, v97, 16, v96
    s_waitcnt vmcnt(28)
    v_lshl_or_b32 v57, v99, 16, v98
    s_waitcnt vmcnt(26)
    v_lshl_or_b32 v58, v101, 16, v100
    s_waitcnt vmcnt(24)
    v_lshl_or_b32 v59, v103, 16, v102
    s_nop 1
    v_mfma_f32_16x16x32_bf16 v[72:75], v[8:11], v[56:59], v[72:75]
    v_mfma_f32_16x16x32_bf16 v[76:79], v[32:35], v[56:59], v[76:79]
    s_waitcnt vmcnt(22)
    s_nop 0
    v_lshl_or_b32 v60, v105, 16, v104
    s_waitcnt vmcnt(20)
    v_lshl_or_b32 v61, v107, 16, v106
    s_waitcnt vmcnt(18)
    v_lshl_or_b32 v62, v109, 16, v108
    s_waitcnt vmcnt(16)
    v_lshl_or_b32 v63, v111, 16, v110
    s_nop 1
    v_mfma_f32_16x16x32_bf16 v[72:75], v[12:15], v[60:63], v[72:75]
    v_mfma_f32_16x16x32_bf16 v[76:79], v[36:39], v[60:63], v[76:79]
    s_waitcnt vmcnt(14)
    v_lshl_or_b32 v64, v113, 16, v112
    s_waitcnt vmcnt(12)
    v_lshl_or_b32 v65, v115, 16, v114
    s_waitcnt vmcnt(10)
    v_lshl_or_b32 v66, v117, 16, v116
    s_waitcnt vmcnt(8)
    v_lshl_or_b32 v67, v119, 16, v118
    s_nop 1
    v_mfma_f32_16x16x32_bf16 v[72:75], v[16:19], v[64:67], v[72:75]
    s_nop 0
    v_mfma_f32_16x16x32_bf16 v[76:79], v[40:43], v[64:67], v[76:79]
    s_waitcnt vmcnt(6)
    v_lshl_or_b32 v68, v121, 16, v120
    s_waitcnt vmcnt(4)
    v_lshl_or_b32 v69, v123, 16, v122
    s_waitcnt vmcnt(2)
    v_lshl_or_b32 v70, v125, 16, v124
    s_waitcnt vmcnt(0)
    v_lshl_or_b32 v71, v127, 16, v126
    s_nop 1
    s_nop 0
    v_mfma_f32_16x16x32_bf16 v[72:75], v[20:23], v[68:71], v[72:75]
    v_mfma_f32_16x16x32_bf16 v[76:79], v[44:47], v[68:71], v[76:79]
    s_nop 6
    v_cvt_pk_bf16_f32 v72, v72, v73
    v_cvt_pk_bf16_f32 v73, v74, v75
    v_cvt_pk_bf16_f32 v74, v76, v77
    v_cvt_pk_bf16_f32 v75, v78, v79
    buffer_store_dwordx4 v[72:75], v249, s[16:19], s30 offen
K1_EXIT:
    s_endpgm
K1_CODE_END:
.globl k2_kernel
.p2align 8
.type k2_kernel,@function
k2_kernel:
    s_cmp_ge_u32 s2, 216
    s_cbranch_scc1 K2_EXIT
    s_load_dwordx2 s[4:5], s[0:1], 56
    s_load_dwordx2 s[8:9], s[0:1], 40
    v_lshrrev_b32 v248, 6, v0
    v_and_b32 v242, 63, v0
    v_readfirstlane_b32 s12, v248
    v_lshlrev_b32_e64 v210, 4, v242
    s_and_b32 s13, s2, 7
    s_lshr_b32 s14, s2, 3
    v_add_u32 v211, 0x1000, v210
    v_add_u32 v212, 0x2000, v210
    s_mul_i32 s36, s13, 503808
    s_mul_i32 s37, s14, 3
    s_mul_i32 s15, s12, 36864
    s_add_u32 s38, s37, s12
    s_cmp_eq_u32 s12, 3
    s_cselect_b32 s38, 80, s38
    s_cselect_b32 s41, 18432, 0
    s_add_u32 s41, s41, s15
    s_lshr_b32 s39, s38, 1
    s_nop 0
    s_mul_i32 s39, s39, 12288
    s_and_b32 s38, s38, 1
    s_lshl_b32 s38, s38, 11
    s_add_u32 s40, s39, s38
    s_add_u32 s40, s40, s36
    s_mul_i32 s42, s12, 18432
    s_add_u32 s43, s42, 4337664
    s_add_u32 s44, s42, 4325376
    s_lshl_b32 s45, s14, 2
    s_add_u32 s45, s45, s12
    s_mul_i32 s46, s45, 6
    v_min_u32 v144, 5, v242
    v_add_u32 v144, s46, v144
    v_lshlrev_b32 v144, 7, v144
    s_getpc_b64 s[88:89]
K2_PC:
    s_sub_u32 s88, s88, K2_PC-k2_kernel
    s_subb_u32 s89, s89, 0
    s_and_b32 s89, s89, 0xffff
    s_mov_b32 s90, K2_CODE_END-k2_kernel
    s_mov_b32 s91, 0x20000
    s_lshl_b32 s46, s45, 1
    v_and_b32 v145, 1, v242
    v_add_u32 v145, s46, v145
    v_lshlrev_b32 v145, 7, v145
    s_waitcnt lgkmcnt(0)
    s_and_b32 s5, s5, 0xffff
    s_mov_b32 s6, 4587520
    s_mov_b32 s7, 0x20000
    s_add_u32 m0, s41, 24576
    s_and_b32 s9, s9, 0xffff
    buffer_load_dwordx4 v210, s[4:7], s40 offen offset:0 lds
    buffer_load_dwordx4 v210, s[4:7], s40 offen offset:1024 lds
    s_nop 0
    s_add_u32 m0, s41, 26624
    s_mov_b32 s10, 3981312
    buffer_load_dwordx4 v211, s[4:7], s40 offen offset:0 lds
    buffer_load_dwordx4 v211, s[4:7], s40 offen offset:1024 lds
    s_add_u32 m0, s41, 28672
    s_mov_b32 s11, 0x20000
    buffer_load_dwordx4 v212, s[4:7], s40 offen offset:0 lds
    buffer_load_dwordx4 v212, s[4:7], s40 offen offset:1024 lds
    s_mov_b32 s35, 4325376
    buffer_load_dword a255, v144, s[4:7], s35 offen
    buffer_load_dword a254, v145, s[88:91], 0 offen
    buffer_load_dwordx4 v[0:3], v210, s[4:7], s44 offen offset:0
    buffer_load_dwordx4 v[4:7], v210, s[4:7], s44 offen offset:3072
    buffer_load_dwordx4 v[8:11], v211, s[4:7], s44 offen offset:2048
    buffer_load_dwordx4 v[12:15], v212, s[4:7], s44 offen offset:1024
    buffer_load_dwordx4 v[16:19], v210, s[4:7], s43 offen offset:0
    buffer_load_dwordx4 v[20:23], v210, s[4:7], s43 offen offset:3072
    buffer_load_dwordx4 v[24:27], v210, s[4:7], s44 offen offset:1024
    buffer_load_dwordx4 v[28:31], v211, s[4:7], s44 offen offset:0
    v_and_b32 v243, 15, v242
    v_lshrrev_b32 v244, 4, v242
    v_and_b32 v248, 6, v243
    v_xor_b32 v248, v248, v244
    v_lshlrev_b32 v248, 4, v248
    v_lshl_add_u32 v248, v243, 7, v248
    v_add_u32 v204, s15, v248
    v_xor_b32_e64 v205, 64, v204
    v_add_u32 v144, 24576, v248
    v_xor_b32 v145, 64, v144
    v_add_u32 v156, 73728, v144
    v_add_u32 v157, 73728, v145
    v_add_u32 v146, 153600, v248
    v_xor_b32 v147, 64, v146
    s_mul_i32 s45, s12, 122880
    s_add_u32 s45, s45, s36
    s_add_u32 s35, s45, 122880
    s_cmp_ge_u32 s14, 20
    s_cselect_b32 s46, 20, 0
    s_cmp_ge_u32 s14, 10
    s_cselect_b32 s47, 10, 0
    s_max_u32 s46, s46, s47
    s_sub_u32 s46, s14, s46
    s_mul_i32 s46, s46, 12288
    s_add_u32 s16, s45, s46
    s_add_u32 s17, s16, 12288
    s_cmp_eq_u32 s17, s35
    s_cselect_b32 s17, s45, s17
    s_add_u32 s18, s17, 12288
    s_cmp_eq_u32 s18, s35
    s_cselect_b32 s18, s45, s18
    s_add_u32 s19, s18, 12288
    s_cmp_eq_u32 s19, s35
    s_cselect_b32 s19, s45, s19
    s_add_u32 s20, s19, 12288
    s_cmp_eq_u32 s20, s35
    s_cselect_b32 s20, s45, s20
    s_add_u32 s21, s20, 12288
    s_cmp_eq_u32 s21, s35
    s_cselect_b32 s21, s45, s21
    s_add_u32 s22, s21, 12288
    s_cmp_eq_u32 s22, s35
    s_cselect_b32 s22, s45, s22
    s_add_u32 s23, s22, 12288
    s_cmp_eq_u32 s23, s35
    s_cselect_b32 s23, s45, s23
    s_add_u32 s24, s23, 12288
    s_cmp_eq_u32 s24, s35
    s_cselect_b32 s24, s45, s24
    s_add_u32 s25, s24, 12288
    s_cmp_eq_u32 s25, s35
    s_cselect_b32 s25, s45, s25
    v_lshrrev_b32 v249, 2, v243
    v_lshl_add_u32 v249, v244, 2, v249
    v_and_b32 v250, 6, v249
    v_lshlrev_b32 v250, 4, v250
    v_lshl_add_u32 v250, v249, 7, v250
    v_and_b32 v251, 3, v243
    v_lshl_add_u32 v250, v251, 3, v250
    v_xor_b32 v251, 0, v250
    v_add_u32 v206, s15, v251
    v_add_u32 v149, 153600, v251
    v_xor_b32 v251, 32, v250
    v_add_u32 v207, s15, v251
    v_add_u32 v150, 153600, v251
    v_xor_b32 v251, 64, v250
    v_add_u32 v208, s15, v251
    v_add_u32 v151, 153600, v251
    v_xor_b32 v251, 96, v250
    v_add_u32 v209, s15, v251
    v_add_u32 v152, 153600, v251
    v_add_u32 v148, 135168, v210
    s_mul_i32 s40, s12, 3
    s_add_u32 s38, s40, 0
    s_lshr_b32 s39, s38, 1
    s_mul_i32 s39, s39, 3072
    s_and_b32 s38, s38, 1
    s_lshl_b32 s38, s38, 3
    s_add_u32 s38, s38, s39
    s_add_u32 s38, s38, 135168
    v_add_u32 v153, s38, v210
    s_add_u32 s38, s40, 1
    s_lshr_b32 s39, s38, 1
    s_mul_i32 s39, s39, 3072
    s_and_b32 s38, s38, 1
    s_lshl_b32 s38, s38, 3
    s_add_u32 s38, s38, s39
    s_add_u32 s38, s38, 135168
    v_add_u32 v154, s38, v210
    s_add_u32 s38, s40, 2
    s_lshr_b32 s39, s38, 1
    s_mul_i32 s39, s39, 3072
    s_and_b32 s38, s38, 1
    s_lshl_b32 s38, s38, 3
    s_add_u32 s38, s38, s39
    s_add_u32 s38, s38, 135168
    v_add_u32 v155, s38, v210
    v_mov_b32 v248, 0x3f803f80
    v_accvgpr_write_b32 a84, v248
    v_accvgpr_write_b32 a85, v248
    v_accvgpr_write_b32 a86, v248
    v_accvgpr_write_b32 a87, v248
    v_mov_b32 v192, 0
    v_mov_b32 v193, 0
    v_mov_b32 v194, 0
    v_mov_b32 v195, 0
    v_mov_b32 v196, 0
    v_mov_b32 v197, 0
    v_mov_b32 v198, 0
    v_mov_b32 v199, 0
    v_mov_b32 v200, 0
    v_mov_b32 v201, 0
    v_mov_b32 v202, 0
    v_mov_b32 v203, 0
    s_mov_b32 s26, 0
    s_cmp_eq_u32 s12, 1
    s_cbranch_scc1 K2_VAD_1
    s_cmp_eq_u32 s12, 2
    s_cbranch_scc1 K2_VAD_2
    s_cmp_eq_u32 s12, 3
    s_cbranch_scc1 K2_VAD_3
    v_add_u32 v214, 0, v209
    v_add_u32 v215, 4096, v206
    v_add_u32 v216, 4096, v207
    v_add_u32 v217, 4096, v208
    v_add_u32 v218, 4096, v209
    v_add_u32 v219, 8192, v206
    v_add_u32 v220, 8192, v207
    v_add_u32 v221, 8192, v208
    v_add_u32 v222, 8192, v209
    v_add_u32 v223, 0, v206
    v_add_u32 v224, 0, v207
    v_add_u32 v225, 0, v208
    s_branch K2_VAD_END
K2_VAD_1:
    v_add_u32 v214, 4096, v208
    v_add_u32 v215, 4096, v209
    v_add_u32 v216, 8192, v206
    v_add_u32 v217, 8192, v207
    v_add_u32 v218, 8192, v208
    v_add_u32 v219, 8192, v209
    v_add_u32 v220, 0, v206
    v_add_u32 v221, 0, v207
    v_add_u32 v222, 0, v208
    v_add_u32_e64 v223, 0, v209
    v_add_u32 v224, 4096, v206
    v_add_u32 v225, 4096, v207
    s_branch K2_VAD_END
K2_VAD_2:
    v_add_u32 v214, 8192, v207
    v_add_u32 v215, 8192, v208
    v_add_u32 v216, 8192, v209
    v_add_u32 v217, 0, v206
    v_add_u32 v218, 0, v207
    v_add_u32 v219, 0, v208
    v_add_u32 v220, 0, v209
    v_add_u32 v221, 4096, v206
    v_add_u32 v222, 4096, v207
    v_add_u32 v223, 4096, v208
    v_add_u32 v224, 4096, v209
    v_add_u32 v225, 8192, v206
    s_branch K2_VAD_END
K2_VAD_3:
    v_add_u32 v214, 0, v206
    v_add_u32 v215, 0, v207
    v_add_u32 v216, 0, v208
    v_add_u32_e64 v217, 0, v209
    v_add_u32 v218, 4096, v206
    v_add_u32 v219, 4096, v207
    v_add_u32 v220, 4096, v208
    v_add_u32 v221, 4096, v209
    v_add_u32 v222, 8192, v206
    v_add_u32 v223, 8192, v207
    v_add_u32 v224, 8192, v208
    v_add_u32 v225, 8192, v209
K2_VAD_END:
    s_add_u32 s33, s42, 4456448
    s_add_u32 s34, s42, 4468736
    buffer_load_dwordx4 v[32:35], v211, s[4:7], s44 offen offset:3072
    buffer_load_dwordx4 v[36:39], v212, s[4:7], s44 offen offset:2048
    buffer_load_dwordx4 v[40:43], v210, s[4:7], s43 offen offset:1024
    buffer_load_dwordx4 v[44:47], v211, s[4:7], s43 offen offset:0
    buffer_load_dwordx4 v[48:51], v210, s[4:7], s44 offen offset:2048
    buffer_load_dwordx4 v[52:55], v211, s[4:7], s44 offen offset:1024
    buffer_load_dwordx4 v[56:59], v212, s[4:7], s44 offen offset:0
    buffer_load_dwordx4 v[60:63], v212, s[4:7], s44 offen offset:3072
    s_waitcnt vmcnt(18)
    s_barrier
    ds_read_b128 a[160:163], v144 offset:0
    ds_read_b128 a[164:167], v144 offset:36864
    ds_read_b128 a[168:171], v156 offset:0
    ds_read_b128 a[172:175], v145 offset:0
    ds_read_b128 a[176:179], v145 offset:36864
    ds_read_b128 a[180:183], v157 offset:0
    ds_read_b128 a[184:187], v144 offset:2048
    ds_read_b128 a[188:191], v144 offset:38912
    ds_read_b128 a[192:195], v156 offset:2048
    buffer_load_dwordx4 v[64:67], v210, s[4:7], s43 offen offset:2048
    buffer_load_dwordx4 v[68:71], v211, s[4:7], s43 offen offset:1024
    s_waitcnt vmcnt(17) lgkmcnt(8)
    v_mfma_f32_16x16x32_bf16 v[72:75], v[0:3], a[160:163], 0
    ds_read_b128 a[196:199], v145 offset:2048
    s_waitcnt lgkmcnt(8)
    v_mfma_f32_16x16x32_bf16 v[76:79], v[0:3], a[164:167], 0
    ds_read_b128 a[200:203], v145 offset:38912
    s_waitcnt lgkmcnt(8)
    v_mfma_f32_16x16x32_bf16 v[80:83], v[0:3], a[168:171], 0
    ds_read_b128 a[204:207], v157 offset:2048
    s_waitcnt vmcnt(16) lgkmcnt(8)
    v_mfma_f32_16x16x32_bf16 v[72:75], v[4:7], a[172:175], v[72:75]
    ds_read_b128 a[208:211], v144 offset:4096
    s_waitcnt lgkmcnt(8)
    v_mfma_f32_16x16x32_bf16 v[76:79], v[4:7], a[176:179], v[76:79]
    ds_read_b128 a[212:215], v144 offset:40960
    s_waitcnt lgkmcnt(8)
    v_mfma_f32_16x16x32_bf16 v[80:83], v[4:7], a[180:183], v[80:83]
    ds_read_b128 a[216:219], v156 offset:4096
    s_waitcnt vmcnt(15) lgkmcnt(8)
    v_mfma_f32_16x16x32_bf16 v[72:75], v[8:11], a[184:187], v[72:75]
    ds_read_b128 a[220:223], v145 offset:4096
    s_waitcnt lgkmcnt(8)
    v_mfma_f32_16x16x32_bf16 v[76:79], v[8:11], a[188:191], v[76:79]
    ds_read_b128 a[224:227], v145 offset:40960
    s_waitcnt lgkmcnt(8)
    s_nop 0
    v_mfma_f32_16x16x32_bf16 v[80:83], v[8:11], a[192:195], v[80:83]
    ds_read_b128 a[228:231], v157 offset:4096
    s_waitcnt vmcnt(14) lgkmcnt(8)
    v_mfma_f32_16x16x32_bf16 v[72:75], v[12:15], a[196:199], v[72:75]
    s_waitcnt lgkmcnt(7)
    v_mfma_f32_16x16x32_bf16 v[76:79], v[12:15], a[200:203], v[76:79]
    s_waitcnt lgkmcnt(6)
    v_mfma_f32_16x16x32_bf16 v[80:83], v[12:15], a[204:207], v[80:83]
    s_waitcnt vmcnt(13) lgkmcnt(5)
    v_mfma_f32_16x16x32_bf16 v[72:75], v[16:19], a[208:211], v[72:75]
    s_waitcnt lgkmcnt(4)
    v_mfma_f32_16x16x32_bf16 v[76:79], v[16:19], a[212:215], v[76:79]
    s_waitcnt lgkmcnt(3)
    v_mfma_f32_16x16x32_bf16 v[80:83], v[16:19], a[216:219], v[80:83]
    s_waitcnt vmcnt(12) lgkmcnt(2)
    v_mfma_f32_16x16x32_bf16 v[72:75], v[20:23], a[220:223], v[72:75]
    s_waitcnt lgkmcnt(1)
    v_mfma_f32_16x16x32_bf16 v[76:79], v[20:23], a[224:227], v[76:79]
    s_waitcnt lgkmcnt(0)
    v_mfma_f32_16x16x32_bf16 v[80:83], v[20:23], a[228:231], v[80:83]
    s_waitcnt vmcnt(11)
    v_mfma_f32_16x16x32_bf16 v[84:87], v[24:27], a[160:163], 0
    ds_read_b128 a[112:115], v146 offset:0
    v_mfma_f32_16x16x32_bf16 v[88:91], v[24:27], a[164:167], 0
    ds_read_b128 a[116:119], v147 offset:0
    v_mfma_f32_16x16x32_bf16 v[92:95], v[24:27], a[168:171], 0
    s_waitcnt vmcnt(10)
    v_mfma_f32_16x16x32_bf16 v[84:87], v[28:31], a[172:175], v[84:87]
    ds_read_b128 a[120:123], v146 offset:2048
    s_nop 0
    v_mfma_f32_16x16x32_bf16 v[88:91], v[28:31], a[176:179], v[88:91]
    ds_read_b128 a[124:127], v147 offset:2048
    v_mfma_f32_16x16x32_bf16 v[92:95], v[28:31], a[180:183], v[92:95]
    s_waitcnt vmcnt(9)
    v_mfma_f32_16x16x32_bf16 v[84:87], v[32:35], a[184:187], v[84:87]
    v_cvt_pk_bf16_f32 v72, v72, v73
    ds_read_b128 a[128:131], v146 offset:4096
    v_mfma_f32_16x16x32_bf16 v[88:91], v[32:35], a[188:191], v[88:91]
    s_nop 0
    ds_read_b128 a[132:135], v147 offset:4096
    s_add_u32 m0, s15, 0
    s_nop 0
    buffer_load_dwordx4 v210, s[4:7], s16 offen offset:0 lds
    v_mfma_f32_16x16x32_bf16 v[92:95], v[32:35], a[192:195], v[92:95]
    v_cvt_pk_bf16_f32 v73, v74, v75
    ds_write_b64 v153, v[72:73] offset:0
    s_waitcnt vmcnt(9)
    v_mfma_f32_16x16x32_bf16 v[84:87], v[36:39], a[196:199], v[84:87]
    s_nop 0
    v_cvt_pk_bf16_f32 v76, v76, v77
    v_mfma_f32_16x16x32_bf16 v[88:91], v[36:39], a[200:203], v[88:91]
    ds_read_b64_tr_b16 a[136:137], v149 offset:0
    buffer_load_dwordx4 v210, s[4:7], s16 offen offset:1024 lds
    v_mfma_f32_16x16x32_bf16 v[92:95], v[36:39], a[204:207], v[92:95]
    v_cvt_pk_bf16_f32 v77, v78, v79
    ds_write_b64 v153, v[76:77] offset:1024
    s_waitcnt vmcnt(9)
    s_nop 0
    v_mfma_f32_16x16x32_bf16 v[84:87], v[40:43], a[208:211], v[84:87]
    v_cvt_pk_bf16_f32 v80, v80, v81
    v_mfma_f32_16x16x32_bf16 v[88:91], v[40:43], a[212:215], v[88:91]
    ds_read_b64_tr_b16 a[138:139], v150 offset:0
    buffer_load_dwordx4 v210, s[4:7], s16 offen offset:2048 lds
    v_mfma_f32_16x16x32_bf16 v[92:95], v[40:43], a[216:219], v[92:95]
    v_cvt_pk_bf16_f32 v81, v82, v83
    ds_write_b64 v153, v[80:81] offset:2048
    s_waitcnt vmcnt(9)
    v_mfma_f32_16x16x32_bf16 v[84:87], v[44:47], a[220:223], v[84:87]
    v_mfma_f32_16x16x32_bf16 v[88:91], v[44:47], a[224:227], v[88:91]
    ds_read_b64_tr_b16 a[140:141], v151 offset:0
    buffer_load_dwordx4 v210, s[4:7], s16 offen offset:3072 lds
    v_mfma_f32_16x16x32_bf16 v[92:95], v[44:47], a[228:231], v[92:95]
    s_waitcnt vmcnt(9)
    v_mfma_f32_16x16x32_bf16 v[96:99], v[48:51], a[160:163], 0
    ds_read_b64_tr_b16 a[142:143], v152 offset:0
    v_mfma_f32_16x16x32_bf16 v[100:103], v[48:51], a[164:167], 0
    ds_read_b64_tr_b16 a[144:145], v149 offset:2048
    s_add_u32 m0, s15, 4096
    s_nop 0
    buffer_load_dwordx4 v211, s[4:7], s16 offen offset:0 lds
    v_mfma_f32_16x16x32_bf16 v[104:107], v[48:51], a[168:171], 0
    s_waitcnt vmcnt(9)
    v_mfma_f32_16x16x32_bf16 v[96:99], v[52:55], a[172:175], v[96:99]
    ds_read_b64_tr_b16 a[146:147], v150 offset:2048
    v_mfma_f32_16x16x32_bf16 v[100:103], v[52:55], a[176:179], v[100:103]
    ds_read_b64_tr_b16 a[148:149], v151 offset:2048
    buffer_load_dwordx4 v211, s[4:7], s16 offen offset:1024 lds
    v_mfma_f32_16x16x32_bf16 v[104:107], v[52:55], a[180:183], v[104:107]
    s_waitcnt vmcnt(9)
    v_mfma_f32_16x16x32_bf16 v[96:99], v[56:59], a[184:187], v[96:99]
    v_cvt_pk_bf16_f32 v84, v84, v85
    ds_read_b64_tr_b16 a[150:151], v152 offset:2048
    s_nop 0
    v_mfma_f32_16x16x32_bf16 v[100:103], v[56:59], a[188:191], v[100:103]
    ds_read_b64_tr_b16 a[152:153], v149 offset:4096
    buffer_load_dwordx4 v211, s[4:7], s16 offen offset:2048 lds
    v_mfma_f32_16x16x32_bf16 v[104:107], v[56:59], a[192:195], v[104:107]
    v_cvt_pk_bf16_f32 v85, v86, v87
    ds_write_b64 v154, v[84:85] offset:0
    s_waitcnt vmcnt(9)
    v_mfma_f32_16x16x32_bf16 v[96:99], v[60:63], a[196:199], v[96:99]
    s_nop 0
    v_cvt_pk_bf16_f32 v88, v88, v89
    v_mfma_f32_16x16x32_bf16 v[100:103], v[60:63], a[200:203], v[100:103]
    ds_read_b64_tr_b16 a[154:155], v150 offset:4096
    buffer_load_dwordx4 v211, s[4:7], s16 offen offset:3072 lds
    v_mfma_f32_16x16x32_bf16 v[104:107], v[60:63], a[204:207], v[104:107]
    v_cvt_pk_bf16_f32 v89, v90, v91
    ds_write_b64 v154, v[88:89] offset:1024
    s_waitcnt vmcnt(9)
    s_nop 0
    v_mfma_f32_16x16x32_bf16 v[96:99], v[64:67], a[208:211], v[96:99]
    v_cvt_pk_bf16_f32 v92, v92, v93
    v_mfma_f32_16x16x32_bf16 v[100:103], v[64:67], a[212:215], v[100:103]
    ds_read_b64_tr_b16 a[156:157], v151 offset:4096
    s_add_u32 m0, s15, 8192
    s_nop 0
    buffer_load_dwordx4 v212, s[4:7], s16 offen offset:0 lds
    v_mfma_f32_16x16x32_bf16 v[104:107], v[64:67], a[216:219], v[104:107]
    s_nop 0
    v_cvt_pk_bf16_f32 v93, v94, v95
    ds_write_b64 v154, v[92:93] offset:2048
    s_waitcnt vmcnt(9)
    v_mfma_f32_16x16x32_bf16 v[96:99], v[68:71], a[220:223], v[96:99]
    v_mfma_f32_16x16x32_bf16 v[100:103], v[68:71], a[224:227], v[100:103]
    ds_read_b64_tr_b16 a[158:159], v152 offset:4096
    buffer_load_dwordx4 v212, s[4:7], s16 offen offset:1024 lds
    v_mfma_f32_16x16x32_bf16 v[104:107], v[68:71], a[228:231], v[104:107]
    s_nop 3
    v_cvt_pk_bf16_f32 v96, v96, v97
    v_cvt_pk_bf16_f32 v97, v98, v99
    ds_write_b64 v155, v[96:97] offset:0
    v_cvt_pk_bf16_f32 v100, v100, v101
    v_cvt_pk_bf16_f32 v101, v102, v103
    ds_write_b64 v155, v[100:101] offset:1024
    v_cvt_pk_bf16_f32 v104, v104, v105
    v_cvt_pk_bf16_f32 v105, v106, v107
    ds_write_b64 v155, v[104:105] offset:2048
    s_waitcnt lgkmcnt(0)
    s_barrier
    ds_read_b128 a[0:3], v148 offset:0
    ds_read_b128 a[4:7], v148 offset:1024
    ds_read_b128 a[8:11], v148 offset:2048
    buffer_load_dwordx4 v212, s[4:7], s16 offen offset:2048 lds
    buffer_load_dwordx4 v212, s[4:7], s16 offen offset:3072 lds
    ds_read_b128 a[12:15], v148 offset:3072
    ds_read_b128 a[16:19], v148 offset:4096
    ds_read_b128 a[20:23], v148 offset:5120
    s_add_u32 m0, s15, 12288
    s_nop 0
    buffer_load_dwordx4 v210, s[4:7], s17 offen offset:0 lds
    buffer_load_dwordx4 v210, s[4:7], s17 offen offset:1024 lds
    ds_read_b128 a[24:27], v148 offset:6144
    ds_read_b128 a[28:31], v148 offset:7168
    s_nop 0
    ds_read_b128 a[32:35], v148 offset:8192
    buffer_load_dwordx4 v210, s[4:7], s17 offen offset:2048 lds
    buffer_load_dwordx4 v210, s[4:7], s17 offen offset:3072 lds
    ds_read_b128 a[36:39], v148 offset:9216
    ds_read_b128 a[40:43], v148 offset:10240
    ds_read_b128 a[44:47], v148 offset:11264
    s_add_u32 m0, s15, 16384
    s_nop 0
    s_nop 0
    buffer_load_dwordx4 v211, s[4:7], s17 offen offset:0 lds
    buffer_load_dwordx4 v211, s[4:7], s17 offen offset:1024 lds
    ds_read_b128 a[48:51], v148 offset:12288
    ds_read_b128 a[52:55], v148 offset:13312
    ds_read_b128 a[56:59], v148 offset:14336
    ds_read_b128 a[60:63], v148 offset:15360
    ds_read_b128 a[64:67], v148 offset:16384
    ds_read_b128 a[68:71], v148 offset:17408
K2_RUN:
    s_waitcnt vmcnt(14)
    ds_read_b128 a[88:91], v204 offset:0
    ds_read_b128 a[92:95], v204 offset:2048
    ds_read_b128 a[96:99], v205 offset:0
    ds_read_b128 a[100:103], v205 offset:2048
    s_waitcnt lgkmcnt(3)
    v_mfma_f32_16x16x32_bf16 v[144:147], a[88:91], a[0:3], v[192:195]
    s_waitcnt vmcnt(10)
    ds_read_b128 a[104:107], v204 offset:4096
    s_nop 0
    v_mfma_f32_16x16x32_bf16 v[152:155], a[88:91], a[4:7], v[196:199]
    s_mul_i32 s36, s13, 503808
    s_mul_i32 s37, s14, 3
    v_mfma_f32_16x16x32_bf16 v[160:163], a[88:91], a[8:11], v[200:203]
    s_waitcnt lgkmcnt(3)
    buffer_load_dwordx4 v211, s[4:7], s17 offen offset:2048 lds
    v_mfma_f32_16x16x32_bf16 v[148:151], a[92:95], a[0:3], v[192:195]
    ds_read_b128 a[108:111], v204 offset:6144
    v_mfma_f32_16x16x32_bf16 v[156:159], a[92:95], a[4:7], v[196:199]
    s_add_u32 s38, s37, 0
    s_lshr_b32 s39, s38, 1
    v_mfma_f32_16x16x32_bf16 v[164:167], a[92:95], a[8:11], v[200:203]
    s_waitcnt lgkmcnt(3)
    buffer_load_dwordx4 v211, s[4:7], s17 offen offset:3072 lds
    v_mfma_f32_16x16x32_bf16 v[144:147], a[96:99], a[12:15], v[144:147]
    ds_read_b128 a[88:91], v205 offset:4096
    v_mfma_f32_16x16x32_bf16 v[152:155], a[96:99], a[16:19], v[152:155]
    s_add_u32 m0, s15, 20480
    s_nop 0
    s_mul_i32 s39, s39, 12288
    v_mfma_f32_16x16x32_bf16 v[160:163], a[96:99], a[20:23], v[160:163]
    s_waitcnt lgkmcnt(3)
    buffer_load_dwordx4 v212, s[4:7], s17 offen offset:0 lds
    v_mfma_f32_16x16x32_bf16 v[148:151], a[100:103], a[12:15], v[148:151]
    ds_read_b128 a[92:95], v205 offset:6144
    v_mfma_f32_16x16x32_bf16 v[156:159], a[100:103], a[16:19], v[156:159]
    s_and_b32 s38, s38, 1
    s_lshl_b32 s38, s38, 11
    s_nop 0
    v_mfma_f32_16x16x32_bf16 v[164:167], a[100:103], a[20:23], v[164:167]
    s_waitcnt lgkmcnt(3)
    buffer_load_dwordx4 v212, s[4:7], s17 offen offset:1024 lds
    v_mfma_f32_16x16x32_bf16 v[144:147], a[104:107], a[24:27], v[144:147]
    s_waitcnt vmcnt(10)
    ds_read_b128 a[96:99], v204 offset:8192
    v_mfma_f32_16x16x32_bf16 v[152:155], a[104:107], a[28:31], v[152:155]
    s_add_u32 s39, s39, s38
    s_add_u32 s27, s39, s36
    v_mfma_f32_16x16x32_bf16 v[160:163], a[104:107], a[32:35], v[160:163]
    s_waitcnt lgkmcnt(3)
    buffer_load_dwordx4 v212, s[4:7], s17 offen offset:2048 lds
    v_mfma_f32_16x16x32_bf16 v[148:151], a[108:111], a[24:27], v[148:151]
    ds_read_b128 a[100:103], v204 offset:10240
    v_mfma_f32_16x16x32_bf16 v[156:159], a[108:111], a[28:31], v[156:159]
    s_add_u32 s38, s37, 1
    s_lshr_b32 s39, s38, 1
    v_mfma_f32_16x16x32_bf16 v[164:167], a[108:111], a[32:35], v[164:167]
    s_waitcnt lgkmcnt(3)
    s_barrier
    s_nop 0
    buffer_load_dwordx4 v212, s[4:7], s17 offen offset:3072 lds
    v_mfma_f32_16x16x32_bf16 v[144:147], a[88:91], a[36:39], v[144:147]
    ds_read_b128 a[104:107], v205 offset:8192
    v_mfma_f32_16x16x32_bf16 v[152:155], a[88:91], a[40:43], v[152:155]
    s_add_u32 m0, s15, 24576
    s_mul_i32 s39, s39, 12288
    v_mfma_f32_16x16x32_bf16 v[160:163], a[88:91], a[44:47], v[160:163]
    s_waitcnt lgkmcnt(3)
    s_nop 0
    buffer_load_dwordx4 v210, s[4:7], s18 offen offset:0 lds
    v_mfma_f32_16x16x32_bf16 v[148:151], a[92:95], a[36:39], v[148:151]
    ds_read_b128 a[108:111], v205 offset:10240
    v_mfma_f32_16x16x32_bf16 v[156:159], a[92:95], a[40:43], v[156:159]
    s_and_b32 s38, s38, 1
    s_lshl_b32 s38, s38, 11
    v_mfma_f32_16x16x32_bf16 v[164:167], a[92:95], a[44:47], v[164:167]
    s_waitcnt lgkmcnt(3)
    buffer_load_dwordx4 v210, s[4:7], s18 offen offset:1024 lds
    s_nop 0
    v_mfma_f32_16x16x32_bf16 v[144:147], a[96:99], a[48:51], v[144:147]
    s_waitcnt vmcnt(10)
    ds_read_b128 a[88:91], v204 offset:12288
    v_mfma_f32_16x16x32_bf16 v[152:155], a[96:99], a[52:55], v[152:155]
    s_add_u32 s39, s39, s38
    s_add_u32 s28, s39, s36
    v_mfma_f32_16x16x32_bf16 v[160:163], a[96:99], a[56:59], v[160:163]
    s_waitcnt lgkmcnt(3)
    buffer_load_dwordx4 v210, s[4:7], s18 offen offset:2048 lds
    v_mfma_f32_16x16x32_bf16 v[148:151], a[100:103], a[48:51], v[148:151]
    ds_read_b128 a[92:95], v204 offset:14336
    v_mfma_f32_16x16x32_bf16 v[156:159], a[100:103], a[52:55], v[156:159]
    s_add_u32 s38, s37, 2
    s_lshr_b32 s39, s38, 1
    v_mfma_f32_16x16x32_bf16 v[164:167], a[100:103], a[56:59], v[164:167]
    s_waitcnt lgkmcnt(3)
    buffer_load_dwordx4 v210, s[4:7], s18 offen offset:3072 lds
    v_mfma_f32_16x16x32_bf16 v[144:147], a[104:107], a[60:63], v[144:147]
    ds_read_b128 a[96:99], v205 offset:12288
    s_nop 0
    v_mfma_f32_16x16x32_bf16 v[152:155], a[104:107], a[64:67], v[152:155]
    s_add_u32 m0, s15, 28672
    s_mul_i32 s39, s39, 12288
    v_mfma_f32_16x16x32_bf16 v[160:163], a[104:107], a[68:71], v[160:163]
    s_waitcnt lgkmcnt(3)
    buffer_load_dwordx4 v211, s[4:7], s18 offen offset:0 lds
    v_mfma_f32_16x16x32_bf16 v[148:151], a[108:111], a[60:63], v[148:151]
    ds_read_b128 a[100:103], v205 offset:14336
    s_nop 0
    v_mfma_f32_16x16x32_bf16 v[156:159], a[108:111], a[64:67], v[156:159]
    s_and_b32 s38, s38, 1
    s_lshl_b32 s38, s38, 11
    v_mfma_f32_16x16x32_bf16 v[164:167], a[108:111], a[68:71], v[164:167]
    s_waitcnt lgkmcnt(3)
    buffer_load_dwordx4 v211, s[4:7], s18 offen offset:1024 lds
    s_cmp_eq_u32 s12, 3
    s_cbranch_scc1 K2_QKH_END
    s_cmp_eq_u32 s12, 1
    s_cbranch_scc1 K2_QKH_1
    s_cmp_eq_u32 s12, 2
    s_cbranch_scc1 K2_QKH_2
    s_nop 0
    v_mfma_f32_16x16x32_bf16 v[238:241], a[112:115], a[0:3], v[192:195]
    v_mfma_f32_16x16x32_bf16 v[238:241], a[116:119], a[12:15], v[238:241]
    v_mfma_f32_16x16x32_bf16 v[238:241], a[120:123], a[24:27], v[238:241]
    v_mfma_f32_16x16x32_bf16 v[238:241], a[124:127], a[36:39], v[238:241]
    v_mfma_f32_16x16x32_bf16 v[238:241], a[128:131], a[48:51], v[238:241]
    v_mfma_f32_16x16x32_bf16 v[238:241], a[132:135], a[60:63], v[238:241]
    s_branch K2_QKH_END
K2_QKH_1:
    v_mfma_f32_16x16x32_bf16 v[238:241], a[112:115], a[4:7], v[196:199]
    s_nop 0
    v_mfma_f32_16x16x32_bf16 v[238:241], a[116:119], a[16:19], v[238:241]
    v_mfma_f32_16x16x32_bf16 v[238:241], a[120:123], a[28:31], v[238:241]
    v_mfma_f32_16x16x32_bf16 v[238:241], a[124:127], a[40:43], v[238:241]
    v_mfma_f32_16x16x32_bf16 v[238:241], a[128:131], a[52:55], v[238:241]
    v_mfma_f32_16x16x32_bf16 v[238:241], a[132:135], a[64:67], v[238:241]
    s_branch K2_QKH_END
K2_QKH_2:
    v_mfma_f32_16x16x32_bf16 v[238:241], a[112:115], a[8:11], v[200:203]
    v_mfma_f32_16x16x32_bf16 v[238:241], a[116:119], a[20:23], v[238:241]
    s_nop 0
    v_mfma_f32_16x16x32_bf16 v[238:241], a[120:123], a[32:35], v[238:241]
    v_mfma_f32_16x16x32_bf16 v[238:241], a[124:127], a[44:47], v[238:241]
    v_mfma_f32_16x16x32_bf16 v[238:241], a[128:131], a[56:59], v[238:241]
    v_mfma_f32_16x16x32_bf16 v[238:241], a[132:135], a[68:71], v[238:241]
K2_QKH_END:
    v_mfma_f32_16x16x32_bf16 v[168:171], a[88:91], a[0:3], v[192:195]
    s_waitcnt vmcnt(10)
    ds_read_b128 a[104:107], v204 offset:16384
    buffer_load_dwordx4 v211, s[4:7], s18 offen offset:2048 lds
    s_nop 0
    v_mfma_f32_16x16x32_bf16 v[176:179], a[88:91], a[4:7], v[196:199]
    v_exp_f32 v144, v144
    v_mfma_f32_16x16x32_bf16 v[184:187], a[88:91], a[8:11], v[200:203]
    s_waitcnt lgkmcnt(3)
    v_exp_f32_e64 v145, v145
    v_mfma_f32_16x16x32_bf16 v[172:175], a[92:95], a[0:3], v[192:195]
    ds_read_b128 a[108:111], v204 offset:18432
    buffer_load_dwordx4 v211, s[4:7], s18 offen offset:3072 lds
    v_cvt_pk_bf16_f32 v144, v144, v145
    v_mfma_f32_16x16x32_bf16 v[180:183], a[92:95], a[4:7], v[196:199]
    v_exp_f32 v146, v146
    v_mfma_f32_16x16x32_bf16 v[188:191], a[92:95], a[8:11], v[200:203]
    s_waitcnt lgkmcnt(3)
    v_exp_f32_e64 v147, v147
    v_mfma_f32_16x16x32_bf16 v[168:171], a[96:99], a[12:15], v[168:171]
    s_add_u32 m0, s15, 32768
    ds_read_b128 a[88:91], v205 offset:16384
    buffer_load_dwordx4 v212, s[4:7], s18 offen offset:0 lds
    v_cvt_pk_bf16_f32 v145, v146, v147
    v_mfma_f32_16x16x32_bf16 v[176:179], a[96:99], a[16:19], v[176:179]
    v_exp_f32 v148, v148
    v_mfma_f32_16x16x32_bf16 v[184:187], a[96:99], a[20:23], v[184:187]
    s_waitcnt lgkmcnt(3)
    v_exp_f32_e64 v149, v149
    v_mfma_f32_16x16x32_bf16 v[172:175], a[100:103], a[12:15], v[172:175]
    ds_read_b128 a[92:95], v205 offset:18432
    buffer_load_dwordx4 v212, s[4:7], s18 offen offset:1024 lds
    v_cvt_pk_bf16_f32 v146, v148, v149
    v_mfma_f32_16x16x32_bf16 v[180:183], a[100:103], a[16:19], v[180:183]
    v_exp_f32 v150, v150
    v_mfma_f32_16x16x32_bf16 v[188:191], a[100:103], a[20:23], v[188:191]
    s_waitcnt lgkmcnt(3)
    v_exp_f32 v151, v151
    v_mfma_f32_16x16x32_bf16 v[168:171], a[104:107], a[24:27], v[168:171]
    s_waitcnt vmcnt(10)
    ds_read_b128 a[96:99], v204 offset:20480
    buffer_load_dwordx4 v212, s[4:7], s18 offen offset:2048 lds
    v_cvt_pk_bf16_f32 v147, v150, v151
    v_mfma_f32_16x16x32_bf16 v[176:179], a[104:107], a[28:31], v[176:179]
    v_exp_f32 v152, v152
    v_mfma_f32_16x16x32_bf16 v[184:187], a[104:107], a[32:35], v[184:187]
    s_waitcnt lgkmcnt(3)
    v_exp_f32_e64 v153, v153
    v_mfma_f32_16x16x32_bf16 v[172:175], a[108:111], a[24:27], v[172:175]
    ds_read_b128 a[100:103], v204 offset:22528
    buffer_load_dwordx4 v212, s[4:7], s18 offen offset:3072 lds
    v_cvt_pk_bf16_f32 v152, v152, v153
    v_mfma_f32_16x16x32_bf16 v[180:183], a[108:111], a[28:31], v[180:183]
    v_exp_f32 v154, v154
    v_mfma_f32_16x16x32_bf16 v[188:191], a[108:111], a[32:35], v[188:191]
    s_waitcnt lgkmcnt(3)
    v_exp_f32_e64 v155, v155
    v_mfma_f32_16x16x32_bf16 v[168:171], a[88:91], a[36:39], v[168:171]
    ds_read_b128 a[104:107], v205 offset:20480
    v_cvt_pk_bf16_f32 v153, v154, v155
    v_mfma_f32_16x16x32_bf16 v[176:179], a[88:91], a[40:43], v[176:179]
    v_exp_f32 v156, v156
    v_mfma_f32_16x16x32_bf16 v[184:187], a[88:91], a[44:47], v[184:187]
    s_waitcnt lgkmcnt(3)
    v_exp_f32 v157, v157
    v_mfma_f32_16x16x32_bf16 v[172:175], a[92:95], a[36:39], v[172:175]
    ds_read_b128 a[108:111], v205 offset:22528
    v_cvt_pk_bf16_f32 v154, v156, v157
    v_mfma_f32_16x16x32_bf16 v[180:183], a[92:95], a[40:43], v[180:183]
    v_exp_f32 v158, v158
    v_mfma_f32_16x16x32_bf16 v[188:191], a[92:95], a[44:47], v[188:191]
    s_waitcnt lgkmcnt(3)
    v_exp_f32 v159, v159
    v_mfma_f32_16x16x32_bf16 v[168:171], a[96:99], a[48:51], v[168:171]
    ds_read_b64_tr_b16 a[88:89], v214 offset:0
    ds_read_b64_tr_b16 a[90:91], v214 offset:2048
    v_cvt_pk_bf16_f32 v155, v158, v159
    v_mfma_f32_16x16x32_bf16 v[176:179], a[96:99], a[52:55], v[176:179]
    v_exp_f32_e64 v160, v160
    v_mfma_f32_16x16x32_bf16 v[184:187], a[96:99], a[56:59], v[184:187]
    s_waitcnt lgkmcnt(4)
    v_exp_f32 v161, v161
    v_mfma_f32_16x16x32_bf16 v[172:175], a[100:103], a[48:51], v[172:175]
    ds_read_b64_tr_b16 a[92:93], v215 offset:0
    ds_read_b64_tr_b16 a[94:95], v215 offset:2048
    v_cvt_pk_bf16_f32 v160, v160, v161
    v_mfma_f32_16x16x32_bf16 v[180:183], a[100:103], a[52:55], v[180:183]
    v_exp_f32_e64 v162, v162
    v_mfma_f32_16x16x32_bf16 v[188:191], a[100:103], a[56:59], v[188:191]
    s_waitcnt lgkmcnt(5)
    v_exp_f32 v163, v163
    v_mfma_f32_16x16x32_bf16 v[168:171], a[104:107], a[60:63], v[168:171]
    ds_read_b64_tr_b16 a[96:97], v216 offset:0
    ds_read_b64_tr_b16 a[98:99], v216 offset:2048
    v_cvt_pk_bf16_f32 v161, v162, v163
    v_mfma_f32_16x16x32_bf16 v[176:179], a[104:107], a[64:67], v[176:179]
    v_exp_f32_e64 v164, v164
    v_mfma_f32_16x16x32_bf16 v[184:187], a[104:107], a[68:71], v[184:187]
    s_waitcnt lgkmcnt(6)
    v_exp_f32 v165, v165
    v_mfma_f32_16x16x32_bf16 v[172:175], a[108:111], a[60:63], v[172:175]
    ds_read_b64_tr_b16 a[100:101], v217 offset:0
    ds_read_b64_tr_b16 a[102:103], v217 offset:2048
    v_cvt_pk_bf16_f32 v162, v164, v165
    v_mfma_f32_16x16x32_bf16 v[180:183], a[108:111], a[64:67], v[180:183]
    v_exp_f32_e64 v166, v166
    v_mfma_f32_16x16x32_bf16 v[188:191], a[108:111], a[68:71], v[188:191]
    s_waitcnt lgkmcnt(6)
    v_exp_f32 v167, v167
    s_nop 0
    v_cvt_pk_bf16_f32 v163, v166, v167
    v_mfma_f32_16x16x32_bf16 a[72:75], a[84:87], v[144:147], 0
    v_exp_f32 v168, v168
    v_mfma_f32_16x16x32_bf16 a[76:79], a[84:87], v[152:155], 0
    v_exp_f32 v169, v169
    v_mfma_f32_16x16x32_bf16 a[80:83], a[84:87], v[160:163], 0
    v_exp_f32 v170, v170
    v_mfma_f32_16x16x32_bf16 v[0:3], a[88:91], v[144:147], 0
    ds_read_b64_tr_b16 a[104:105], v218 offset:0
    ds_read_b64_tr_b16 a[106:107], v218 offset:2048
    v_mfma_f32_16x16x32_bf16 v[4:7], a[88:91], v[152:155], 0
    v_exp_f32 v171, v171
    v_mfma_f32_16x16x32_bf16 v[8:11], a[88:91], v[160:163], 0
    s_waitcnt lgkmcnt(6)
    v_exp_f32_e64 v238, v238
    v_mfma_f32_16x16x32_bf16 v[12:15], a[92:95], v[144:147], 0
    ds_read_b64_tr_b16 a[108:109], v219 offset:0
    ds_read_b64_tr_b16 a[110:111], v219 offset:2048
    v_mfma_f32_16x16x32_bf16 v[16:19], a[92:95], v[152:155], 0
    v_exp_f32 v172, v172
    v_mfma_f32_16x16x32_bf16 v[20:23], a[92:95], v[160:163], 0
    s_waitcnt lgkmcnt(6)
    v_exp_f32_e64 v239, v239
    v_mfma_f32_16x16x32_bf16 v[24:27], a[96:99], v[144:147], 0
    ds_read_b64_tr_b16 a[88:89], v220 offset:0
    ds_read_b64_tr_b16 a[90:91], v220 offset:2048
    v_mfma_f32_16x16x32_bf16 v[28:31], a[96:99], v[152:155], 0
    v_exp_f32 v173, v173
    v_mfma_f32_16x16x32_bf16 v[32:35], a[96:99], v[160:163], 0
    s_waitcnt lgkmcnt(6)
    v_exp_f32_e64 v240, v240
    v_mfma_f32_16x16x32_bf16 v[36:39], a[100:103], v[144:147], 0
    ds_read_b64_tr_b16 a[92:93], v221 offset:0
    ds_read_b64_tr_b16 a[94:95], v221 offset:2048
    v_mfma_f32_16x16x32_bf16 v[40:43], a[100:103], v[152:155], 0
    v_exp_f32 v174, v174
    v_mfma_f32_16x16x32_bf16 v[44:47], a[100:103], v[160:163], 0
    s_waitcnt lgkmcnt(6)
    v_exp_f32 v241, v241
    v_mfma_f32_16x16x32_bf16 v[48:51], a[104:107], v[144:147], 0
    ds_read_b64_tr_b16 a[96:97], v222 offset:0
    ds_read_b64_tr_b16 a[98:99], v222 offset:2048
    v_mfma_f32_16x16x32_bf16 v[52:55], a[104:107], v[152:155], 0
    v_exp_f32 v175, v175
    v_mfma_f32_16x16x32_bf16 v[56:59], a[104:107], v[160:163], 0
    s_waitcnt lgkmcnt(6)
    s_add_u32 s39, s39, s38
    v_cvt_pk_bf16_f32 v238, v238, v239
    v_mfma_f32_16x16x32_bf16 v[60:63], a[108:111], v[144:147], 0
    ds_read_b64_tr_b16 a[100:101], v223 offset:0
    ds_read_b64_tr_b16 a[102:103], v223 offset:2048
    v_mfma_f32_16x16x32_bf16 v[64:67], a[108:111], v[152:155], 0
    v_exp_f32_e64 v176, v176
    v_mfma_f32_16x16x32_bf16 v[68:71], a[108:111], v[160:163], 0
    s_waitcnt lgkmcnt(6)
    s_add_u32 s29, s39, s36
    v_cvt_pk_bf16_f32 v168, v168, v169
    v_mfma_f32_16x16x32_bf16 v[72:75], a[88:91], v[144:147], 0
    ds_read_b64_tr_b16 a[104:105], v224 offset:0
    ds_read_b64_tr_b16 a[106:107], v224 offset:2048
    v_mfma_f32_16x16x32_bf16 v[76:79], a[88:91], v[152:155], 0
    v_exp_f32_e64 v177, v177
    v_mfma_f32_16x16x32_bf16 v[80:83], a[88:91], v[160:163], 0
    s_waitcnt lgkmcnt(6)
    s_mul_i32 s36, s12, 6
    v_cvt_pk_bf16_f32 v169, v170, v171
    v_mfma_f32_16x16x32_bf16 v[84:87], a[92:95], v[144:147], 0
    ds_read_b64_tr_b16 a[108:109], v225 offset:0
    ds_read_b64_tr_b16 a[110:111], v225 offset:2048
    v_mfma_f32_16x16x32_bf16 v[88:91], a[92:95], v[152:155], 0
    v_exp_f32_e64 v178, v178
    v_mfma_f32_16x16x32_bf16 v[92:95], a[92:95], v[160:163], 0
    s_waitcnt lgkmcnt(6)
    v_cvt_pk_bf16_f32 v170, v172, v173
    v_add_u32 v248, s36, v244
    v_mfma_f32_16x16x32_bf16 v[96:99], a[96:99], v[144:147], 0
    s_waitcnt vmcnt(8)
    ds_read_b128 a[88:91], v204 offset:24576
    v_mfma_f32_16x16x32_bf16 v[100:103], a[96:99], v[152:155], 0
    v_exp_f32 v179, v179
    v_mfma_f32_16x16x32_bf16 v[104:107], a[96:99], v[160:163], 0
    s_waitcnt lgkmcnt(5)
    v_cvt_pk_bf16_f32 v171, v174, v175
    v_and_b32 v249, 7, v248
    v_mfma_f32_16x16x32_bf16 v[108:111], a[100:103], v[144:147], 0
    ds_read_b128 a[92:95], v204 offset:26624
    v_mfma_f32_16x16x32_bf16 v[112:115], a[100:103], v[152:155], 0
    v_exp_f32 v180, v180
    v_mfma_f32_16x16x32_bf16 v[116:119], a[100:103], v[160:163], 0
    s_waitcnt lgkmcnt(4)
    v_cvt_pk_bf16_f32 v239, v240, v241
    v_and_b32 v250, 6, v243
    v_mfma_f32_16x16x32_bf16 v[120:123], a[104:107], v[144:147], 0
    ds_read_b128 a[96:99], v205 offset:24576
    v_mfma_f32_16x16x32_bf16 v[124:127], a[104:107], v[152:155], 0
    v_exp_f32_e64 v181, v181
    v_mfma_f32_16x16x32_bf16 v[128:131], a[104:107], v[160:163], 0
    s_waitcnt lgkmcnt(3)
    buffer_load_dwordx4 a[160:163], v210, s[4:7], s33 offen offset:0
    v_mfma_f32_16x16x32_bf16 v[132:135], a[108:111], v[144:147], 0
    ds_read_b128 a[100:103], v205 offset:26624
    v_mfma_f32_16x16x32_bf16 v[136:139], a[108:111], v[152:155], 0
    v_exp_f32 v182, v182
    v_mfma_f32_16x16x32_bf16 v[140:143], a[108:111], v[160:163], 0
    s_waitcnt lgkmcnt(3)
    v_xor_b32 v249, v249, v250
    v_lshlrev_b32 v249, 4, v249
    s_cmp_eq_u32 s12, 3
    s_cbranch_scc1 K2_PVH_END
    s_cmp_eq_u32 s12, 1
    s_cbranch_scc1 K2_PVH_1
    s_cmp_eq_u32 s12, 2
    s_cbranch_scc1 K2_PVH_2
    v_mfma_f32_16x16x16_bf16 a[72:75], a[84:85], v[238:239], a[72:75]
    v_mfma_f32_16x16x16_bf16 v[0:3], a[142:143], v[238:239], v[0:3]
    v_mfma_f32_16x16x16_bf16 v[12:15], a[144:145], v[238:239], v[12:15]
    v_mfma_f32_16x16x16_bf16 v[24:27], a[146:147], v[238:239], v[24:27]
    v_mfma_f32_16x16x16_bf16 v[36:39], a[148:149], v[238:239], v[36:39]
    v_mfma_f32_16x16x16_bf16 v[48:51], a[150:151], v[238:239], v[48:51]
    v_mfma_f32_16x16x16_bf16 v[60:63], a[152:153], v[238:239], v[60:63]
    v_mfma_f32_16x16x16_bf16 v[72:75], a[154:155], v[238:239], v[72:75]
    v_mfma_f32_16x16x16_bf16 v[84:87], a[156:157], v[238:239], v[84:87]
    v_mfma_f32_16x16x16_bf16 v[96:99], a[158:159], v[238:239], v[96:99]
    v_mfma_f32_16x16x16_bf16 v[108:111], a[136:137], v[238:239], v[108:111]
    v_mfma_f32_16x16x16_bf16 v[120:123], a[138:139], v[238:239], v[120:123]
    v_mfma_f32_16x16x16_bf16 v[132:135], a[140:141], v[238:239], v[132:135]
    s_branch K2_PVH_END
K2_PVH_1:
    v_mfma_f32_16x16x16_bf16 a[76:79], a[84:85], v[238:239], a[76:79]
    v_mfma_f32_16x16x16_bf16 v[4:7], a[148:149], v[238:239], v[4:7]
    s_nop 0
    v_mfma_f32_16x16x16_bf16 v[16:19], a[150:151], v[238:239], v[16:19]
    v_mfma_f32_16x16x16_bf16 v[28:31], a[152:153], v[238:239], v[28:31]
    v_mfma_f32_16x16x16_bf16 v[40:43], a[154:155], v[238:239], v[40:43]
    v_mfma_f32_16x16x16_bf16 v[52:55], a[156:157], v[238:239], v[52:55]
    v_mfma_f32_16x16x16_bf16 v[64:67], a[158:159], v[238:239], v[64:67]
    v_mfma_f32_16x16x16_bf16 v[76:79], a[136:137], v[238:239], v[76:79]
    v_mfma_f32_16x16x16_bf16 v[88:91], a[138:139], v[238:239], v[88:91]
    v_mfma_f32_16x16x16_bf16 v[100:103], a[140:141], v[238:239], v[100:103]
    v_mfma_f32_16x16x16_bf16 v[112:115], a[142:143], v[238:239], v[112:115]
    v_mfma_f32_16x16x16_bf16 v[124:127], a[144:145], v[238:239], v[124:127]
    v_mfma_f32_16x16x16_bf16 v[136:139], a[146:147], v[238:239], v[136:139]
    s_branch K2_PVH_END
K2_PVH_2:
    v_mfma_f32_16x16x16_bf16 a[80:83], a[84:85], v[238:239], a[80:83]
    v_mfma_f32_16x16x16_bf16 v[8:11], a[154:155], v[238:239], v[8:11]
    v_mfma_f32_16x16x16_bf16 v[20:23], a[156:157], v[238:239], v[20:23]
    v_mfma_f32_16x16x16_bf16 v[32:35], a[158:159], v[238:239], v[32:35]
    s_nop 0
    v_mfma_f32_16x16x16_bf16 v[44:47], a[136:137], v[238:239], v[44:47]
    v_mfma_f32_16x16x16_bf16 v[56:59], a[138:139], v[238:239], v[56:59]
    v_mfma_f32_16x16x16_bf16 v[68:71], a[140:141], v[238:239], v[68:71]
    v_mfma_f32_16x16x16_bf16 v[80:83], a[142:143], v[238:239], v[80:83]
    v_mfma_f32_16x16x16_bf16 v[92:95], a[144:145], v[238:239], v[92:95]
    v_mfma_f32_16x16x16_bf16 v[104:107], a[146:147], v[238:239], v[104:107]
    v_mfma_f32_16x16x16_bf16 v[116:119], a[148:149], v[238:239], v[116:119]
    v_mfma_f32_16x16x16_bf16 v[128:131], a[150:151], v[238:239], v[128:131]
    v_mfma_f32_16x16x16_bf16 v[140:143], a[152:153], v[238:239], v[140:143]
K2_PVH_END:
    v_mfma_f32_16x16x32_bf16 v[144:147], a[88:91], a[0:3], v[192:195]
    s_waitcnt vmcnt(5)
    ds_read_b128 a[104:107], v204 offset:28672
    v_mfma_f32_16x16x32_bf16 v[152:155], a[88:91], a[4:7], v[196:199]
    s_add_u32 m0, s15, 0
    v_exp_f32 v183, v183
    v_mfma_f32_16x16x32_bf16 v[160:163], a[88:91], a[8:11], v[200:203]
    s_waitcnt lgkmcnt(3)
    buffer_load_dwordx4 v210, s[4:7], s19 offen offset:0 lds
    v_mfma_f32_16x16x32_bf16 v[148:151], a[92:95], a[0:3], v[192:195]
    ds_read_b128 a[108:111], v204 offset:30720
    v_cvt_pk_bf16_f32 v176, v176, v177
    v_mfma_f32_16x16x32_bf16 v[156:159], a[92:95], a[4:7], v[196:199]
    v_exp_f32 v184, v184
    v_mfma_f32_16x16x32_bf16 v[164:167], a[92:95], a[8:11], v[200:203]
    s_waitcnt lgkmcnt(3)
    buffer_load_dwordx4 v210, s[4:7], s19 offen offset:1024 lds
    v_mfma_f32_16x16x32_bf16 v[144:147], a[96:99], a[12:15], v[144:147]
    ds_read_b128 a[88:91], v205 offset:28672
    v_cvt_pk_bf16_f32 v177, v178, v179
    v_mfma_f32_16x16x32_bf16 v[152:155], a[96:99], a[16:19], v[152:155]
    v_exp_f32 v185, v185
    v_mfma_f32_16x16x32_bf16 v[160:163], a[96:99], a[20:23], v[160:163]
    s_waitcnt lgkmcnt(3)
    buffer_load_dwordx4 v210, s[4:7], s19 offen offset:2048 lds
    v_mfma_f32_16x16x32_bf16 v[148:151], a[100:103], a[12:15], v[148:151]
    ds_read_b128 a[92:95], v205 offset:30720
    v_cvt_pk_bf16_f32 v178, v180, v181
    v_mfma_f32_16x16x32_bf16 v[156:159], a[100:103], a[16:19], v[156:159]
    v_exp_f32_e64 v186, v186
    v_mfma_f32_16x16x32_bf16 v[164:167], a[100:103], a[20:23], v[164:167]
    s_waitcnt lgkmcnt(3)
    buffer_load_dwordx4 v210, s[4:7], s19 offen offset:3072 lds
    v_mfma_f32_16x16x32_bf16 v[144:147], a[104:107], a[24:27], v[144:147]
    s_waitcnt vmcnt(5)
    ds_read_b128 a[96:99], v204 offset:32768
    v_cvt_pk_bf16_f32 v179, v182, v183
    v_mfma_f32_16x16x32_bf16 v[152:155], a[104:107], a[28:31], v[152:155]
    s_add_u32 m0, s15, 4096
    v_exp_f32 v187, v187
    v_mfma_f32_16x16x32_bf16 v[160:163], a[104:107], a[32:35], v[160:163]
    s_waitcnt lgkmcnt(3)
    buffer_load_dwordx4 v211, s[4:7], s19 offen offset:0 lds
    v_mfma_f32_16x16x32_bf16 v[148:151], a[108:111], a[24:27], v[148:151]
    ds_read_b128 a[100:103], v204 offset:34816
    v_cvt_pk_bf16_f32 v184, v184, v185
    v_mfma_f32_16x16x32_bf16 v[156:159], a[108:111], a[28:31], v[156:159]
    v_exp_f32 v188, v188
    v_mfma_f32_16x16x32_bf16 v[164:167], a[108:111], a[32:35], v[164:167]
    s_waitcnt lgkmcnt(3)
    buffer_load_dwordx4 v211, s[4:7], s19 offen offset:1024 lds
    v_mfma_f32_16x16x32_bf16 v[144:147], a[88:91], a[36:39], v[144:147]
    ds_read_b128 a[104:107], v205 offset:32768
    v_cvt_pk_bf16_f32 v185, v186, v187
    v_mfma_f32_16x16x32_bf16 v[152:155], a[88:91], a[40:43], v[152:155]
    v_exp_f32 v189, v189
    v_mfma_f32_16x16x32_bf16 v[160:163], a[88:91], a[44:47], v[160:163]
    s_waitcnt lgkmcnt(3)
    buffer_load_dwordx4 v211, s[4:7], s19 offen offset:2048 lds
    v_mfma_f32_16x16x32_bf16 v[148:151], a[92:95], a[36:39], v[148:151]
    ds_read_b128 a[108:111], v205 offset:34816
    v_cvt_pk_bf16_f32 v186, v188, v189
    v_mfma_f32_16x16x32_bf16 v[156:159], a[92:95], a[40:43], v[156:159]
    v_exp_f32 v190, v190
    v_mfma_f32_16x16x32_bf16 v[164:167], a[92:95], a[44:47], v[164:167]
    s_waitcnt lgkmcnt(3)
    buffer_load_dwordx4 v211, s[4:7], s19 offen offset:3072 lds
    v_mfma_f32_16x16x32_bf16 v[144:147], a[96:99], a[48:51], v[144:147]
    ds_read_b64_tr_b16 a[88:89], v214 offset:12288
    ds_read_b64_tr_b16 a[90:91], v214 offset:14336
    v_mfma_f32_16x16x32_bf16 v[152:155], a[96:99], a[52:55], v[152:155]
    s_add_u32 m0, s15, 8192
    v_exp_f32 v191, v191
    v_mfma_f32_16x16x32_bf16 v[160:163], a[96:99], a[56:59], v[160:163]
    s_waitcnt lgkmcnt(4)
    buffer_load_dwordx4 v212, s[4:7], s19 offen offset:0 lds
    v_mfma_f32_16x16x32_bf16 v[148:151], a[100:103], a[48:51], v[148:151]
    ds_read_b64_tr_b16 a[92:93], v215 offset:12288
    ds_read_b64_tr_b16 a[94:95], v215 offset:14336
    v_mfma_f32_16x16x32_bf16 v[156:159], a[100:103], a[52:55], v[156:159]
    buffer_load_dwordx4 v212, s[4:7], s19 offen offset:1024 lds
    v_mfma_f32_16x16x32_bf16 v[164:167], a[100:103], a[56:59], v[164:167]
    s_waitcnt lgkmcnt(5)
    v_cvt_pk_bf16_f32 v187, v190, v191
    v_lshl_add_u32 v249, v243, 7, v249
    v_mfma_f32_16x16x32_bf16 v[144:147], a[104:107], a[60:63], v[144:147]
    ds_read_b64_tr_b16 a[96:97], v216 offset:12288
    ds_read_b64_tr_b16 a[98:99], v216 offset:14336
    v_mfma_f32_16x16x32_bf16 v[152:155], a[104:107], a[64:67], v[152:155]
    s_nop 0
    buffer_load_dwordx4 v212, s[4:7], s19 offen offset:2048 lds
    v_mfma_f32_16x16x32_bf16 v[160:163], a[104:107], a[68:71], v[160:163]
    s_waitcnt lgkmcnt(6)
    v_lshrrev_b32 v250, 3, v248
    v_lshl_add_u32 v245, v250, 12, v249
    v_mfma_f32_16x16x32_bf16 v[148:151], a[108:111], a[60:63], v[148:151]
    ds_read_b64_tr_b16 a[100:101], v217 offset:12288
    ds_read_b64_tr_b16 a[102:103], v217 offset:14336
    v_mfma_f32_16x16x32_bf16 v[156:159], a[108:111], a[64:67], v[156:159]
    buffer_load_dwordx4 v212, s[4:7], s19 offen offset:3072 lds
    v_mfma_f32_16x16x32_bf16 v[164:167], a[108:111], a[68:71], v[164:167]
    s_waitcnt lgkmcnt(6)
    v_lshrrev_b32 v248, 1, v244
    v_mfma_f32_16x16x32_bf16 a[72:75], a[84:87], v[168:171], a[72:75]
    v_exp_f32 v144, v144
    v_mfma_f32_16x16x32_bf16 a[76:79], a[84:87], v[176:179], a[76:79]
    v_exp_f32 v145, v145
    v_mfma_f32_16x16x32_bf16 a[80:83], a[84:87], v[184:187], a[80:83]
    v_exp_f32_e64 v146, v146
    v_mfma_f32_16x16x32_bf16 v[0:3], a[88:91], v[168:171], v[0:3]
    ds_read_b64_tr_b16 a[104:105], v218 offset:12288
    ds_read_b64_tr_b16 a[106:107], v218 offset:14336
    v_mfma_f32_16x16x32_bf16 v[4:7], a[88:91], v[176:179], v[4:7]
    v_exp_f32 v147, v147
    v_mfma_f32_16x16x32_bf16 v[8:11], a[88:91], v[184:187], v[8:11]
    s_waitcnt lgkmcnt(6)
    s_add_u32 s37, s36, 4
    v_add_u32 v248, s37, v248
    v_and_b32_e64 v249, 7, v248
    v_mfma_f32_16x16x32_bf16 v[12:15], a[92:95], v[168:171], v[12:15]
    ds_read_b64_tr_b16 a[108:109], v219 offset:12288
    ds_read_b64_tr_b16 a[110:111], v219 offset:14336
    v_mfma_f32_16x16x32_bf16 v[16:19], a[92:95], v[176:179], v[16:19]
    v_exp_f32 v148, v148
    v_mfma_f32_16x16x32_bf16 v[20:23], a[92:95], v[184:187], v[20:23]
    s_waitcnt lgkmcnt(6)
    buffer_load_dwordx4 a[164:167], v210, s[4:7], s33 offen offset:1024
    v_mfma_f32_16x16x32_bf16 v[24:27], a[96:99], v[168:171], v[24:27]
    ds_read_b64_tr_b16 a[88:89], v220 offset:12288
    ds_read_b64_tr_b16 a[90:91], v220 offset:14336
    v_mfma_f32_16x16x32_bf16 v[28:31], a[96:99], v[176:179], v[28:31]
    v_exp_f32 v149, v149
    v_mfma_f32_16x16x32_bf16 v[32:35], a[96:99], v[184:187], v[32:35]
    s_waitcnt lgkmcnt(6)
    v_and_b32 v250, 6, v243
    v_xor_b32 v249, v249, v250
    v_mfma_f32_16x16x32_bf16 v[36:39], a[100:103], v[168:171], v[36:39]
    ds_read_b64_tr_b16 a[92:93], v221 offset:12288
    ds_read_b64_tr_b16 a[94:95], v221 offset:14336
    v_mfma_f32_16x16x32_bf16 v[40:43], a[100:103], v[176:179], v[40:43]
    v_exp_f32 v150, v150
    v_mfma_f32_16x16x32_bf16 v[44:47], a[100:103], v[184:187], v[44:47]
    s_waitcnt lgkmcnt(6)
    buffer_load_dwordx4 a[168:171], v210, s[4:7], s33 offen offset:2048
    v_mfma_f32_16x16x32_bf16 v[48:51], a[104:107], v[168:171], v[48:51]
    ds_read_b64_tr_b16 a[96:97], v222 offset:12288
    ds_read_b64_tr_b16 a[98:99], v222 offset:14336
    v_mfma_f32_16x16x32_bf16 v[52:55], a[104:107], v[176:179], v[52:55]
    v_exp_f32 v151, v151
    v_mfma_f32_16x16x32_bf16 v[56:59], a[104:107], v[184:187], v[56:59]
    s_waitcnt lgkmcnt(6)
    v_lshlrev_b32_e64 v249, 4, v249
    v_lshl_add_u32 v249, v243, 7, v249
    v_mfma_f32_16x16x32_bf16 v[60:63], a[108:111], v[168:171], v[60:63]
    ds_read_b64_tr_b16 a[100:101], v223 offset:12288
    ds_read_b64_tr_b16 a[102:103], v223 offset:14336
    v_mfma_f32_16x16x32_bf16 v[64:67], a[108:111], v[176:179], v[64:67]
    v_exp_f32 v152, v152
    v_mfma_f32_16x16x32_bf16 v[68:71], a[108:111], v[184:187], v[68:71]
    s_waitcnt lgkmcnt(6)
    v_cvt_pk_bf16_f32 v144, v144, v145
    v_lshrrev_b32_e64 v250, 3, v248
    v_mfma_f32_16x16x32_bf16 v[72:75], a[88:91], v[168:171], v[72:75]
    ds_read_b64_tr_b16 a[104:105], v224 offset:12288
    ds_read_b64_tr_b16 a[106:107], v224 offset:14336
    v_mfma_f32_16x16x32_bf16 v[76:79], a[88:91], v[176:179], v[76:79]
    v_exp_f32 v153, v153
    v_mfma_f32_16x16x32_bf16 v[80:83], a[88:91], v[184:187], v[80:83]
    s_waitcnt lgkmcnt(6)
    v_cvt_pk_bf16_f32 v145, v146, v147
    v_lshl_add_u32 v246, v250, 12, v249
    v_mfma_f32_16x16x32_bf16 v[84:87], a[92:95], v[168:171], v[84:87]
    ds_read_b64_tr_b16 a[108:109], v225 offset:12288
    ds_read_b64_tr_b16 a[110:111], v225 offset:14336
    v_mfma_f32_16x16x32_bf16 v[88:91], a[92:95], v[176:179], v[88:91]
    v_exp_f32 v154, v154
    v_mfma_f32_16x16x32_bf16 v[92:95], a[92:95], v[184:187], v[92:95]
    s_waitcnt lgkmcnt(6)
    v_cvt_pk_bf16_f32 v146, v148, v149
    v_and_b32 v248, 1, v244
    v_mfma_f32_16x16x32_bf16 v[96:99], a[96:99], v[168:171], v[96:99]
    s_waitcnt vmcnt(10)
    ds_read_b128 a[88:91], v204 offset:0
    v_mfma_f32_16x16x32_bf16 v[100:103], a[96:99], v[176:179], v[100:103]
    v_exp_f32 v155, v155
    v_mfma_f32_16x16x32_bf16 v[104:107], a[96:99], v[184:187], v[104:107]
    s_waitcnt lgkmcnt(5)
    v_cvt_pk_bf16_f32 v147, v150, v151
    v_lshl_add_u32 v246, v248, 3, v246
    v_mfma_f32_16x16x32_bf16 v[108:111], a[100:103], v[168:171], v[108:111]
    ds_read_b128 a[92:95], v204 offset:2048
    v_mfma_f32_16x16x32_bf16 v[112:115], a[100:103], v[176:179], v[112:115]
    v_exp_f32_e64 v156, v156
    v_mfma_f32_16x16x32_bf16 v[116:119], a[100:103], v[184:187], v[116:119]
    s_waitcnt lgkmcnt(4)
    buffer_load_dwordx4 a[172:175], v210, s[4:7], s33 offen offset:3072
    v_mfma_f32_16x16x32_bf16 v[120:123], a[104:107], v[168:171], v[120:123]
    ds_read_b128 a[96:99], v205 offset:0
    v_mfma_f32_16x16x32_bf16 v[124:127], a[104:107], v[176:179], v[124:127]
    v_exp_f32_e64 v157, v157
    v_mfma_f32_16x16x32_bf16 v[128:131], a[104:107], v[184:187], v[128:131]
    s_waitcnt lgkmcnt(3)
    buffer_load_dwordx4 a[176:179], v211, s[4:7], s33 offen offset:0
    v_mfma_f32_16x16x32_bf16 v[132:135], a[108:111], v[168:171], v[132:135]
    ds_read_b128 a[100:103], v205 offset:2048
    v_mfma_f32_16x16x32_bf16 v[136:139], a[108:111], v[176:179], v[136:139]
    v_exp_f32 v158, v158
    v_mfma_f32_16x16x32_bf16 v[140:143], a[108:111], v[184:187], v[140:143]
    s_waitcnt lgkmcnt(3)
    v_lshlrev_b32 v247, 3, v243
    v_mfma_f32_16x16x32_bf16 v[168:171], a[88:91], a[0:3], v[192:195]
    s_waitcnt vmcnt(8)
    ds_read_b128 a[104:107], v204 offset:4096
    v_mfma_f32_16x16x32_bf16 v[176:179], a[88:91], a[4:7], v[196:199]
    s_add_u32 m0, s15, 12288
    v_exp_f32 v159, v159
    v_mfma_f32_16x16x32_bf16 v[184:187], a[88:91], a[8:11], v[200:203]
    s_waitcnt lgkmcnt(3)
    buffer_load_dwordx4 v210, s[4:7], s20 offen offset:0 lds
    v_mfma_f32_16x16x32_bf16 v[172:175], a[92:95], a[0:3], v[192:195]
    ds_read_b128 a[108:111], v204 offset:6144
    v_cvt_pk_bf16_f32 v152, v152, v153
    v_mfma_f32_16x16x32_bf16 v[180:183], a[92:95], a[4:7], v[196:199]
    v_exp_f32 v160, v160
    v_mfma_f32_16x16x32_bf16 v[188:191], a[92:95], a[8:11], v[200:203]
    s_waitcnt lgkmcnt(3)
    buffer_load_dwordx4 v210, s[4:7], s20 offen offset:1024 lds
    v_mfma_f32_16x16x32_bf16 v[168:171], a[96:99], a[12:15], v[168:171]
    ds_read_b128 a[88:91], v205 offset:4096
    v_cvt_pk_bf16_f32 v153, v154, v155
    v_mfma_f32_16x16x32_bf16 v[176:179], a[96:99], a[16:19], v[176:179]
    v_exp_f32 v161, v161
    v_mfma_f32_16x16x32_bf16 v[184:187], a[96:99], a[20:23], v[184:187]
    s_waitcnt lgkmcnt(3)
    buffer_load_dwordx4 v210, s[4:7], s20 offen offset:2048 lds
    v_mfma_f32_16x16x32_bf16 v[172:175], a[100:103], a[12:15], v[172:175]
    ds_read_b128 a[92:95], v205 offset:6144
    v_cvt_pk_bf16_f32 v154, v156, v157
    v_mfma_f32_16x16x32_bf16 v[180:183], a[100:103], a[16:19], v[180:183]
    v_exp_f32_e64 v162, v162
    v_mfma_f32_16x16x32_bf16 v[188:191], a[100:103], a[20:23], v[188:191]
    s_waitcnt lgkmcnt(3)
    buffer_load_dwordx4 v210, s[4:7], s20 offen offset:3072 lds
    v_mfma_f32_16x16x32_bf16 v[168:171], a[104:107], a[24:27], v[168:171]
    s_waitcnt vmcnt(8)
    ds_read_b128 a[96:99], v204 offset:8192
    v_cvt_pk_bf16_f32 v155, v158, v159
    v_mfma_f32_16x16x32_bf16 v[176:179], a[104:107], a[28:31], v[176:179]
    s_add_u32 m0, s15, 16384
    v_exp_f32 v163, v163
    v_mfma_f32_16x16x32_bf16 v[184:187], a[104:107], a[32:35], v[184:187]
    s_waitcnt lgkmcnt(3)
    buffer_load_dwordx4 v211, s[4:7], s20 offen offset:0 lds
    v_mfma_f32_16x16x32_bf16 v[172:175], a[108:111], a[24:27], v[172:175]
    ds_read_b128 a[100:103], v204 offset:10240
    v_cvt_pk_bf16_f32 v160, v160, v161
    v_mfma_f32_16x16x32_bf16 v[180:183], a[108:111], a[28:31], v[180:183]
    v_exp_f32 v164, v164
    v_mfma_f32_16x16x32_bf16 v[188:191], a[108:111], a[32:35], v[188:191]
    s_waitcnt lgkmcnt(3)
    buffer_load_dwordx4 v211, s[4:7], s20 offen offset:1024 lds
    v_mfma_f32_16x16x32_bf16 v[168:171], a[88:91], a[36:39], v[168:171]
    ds_read_b128 a[104:107], v205 offset:8192
    v_cvt_pk_bf16_f32 v161, v162, v163
    v_mfma_f32_16x16x32_bf16 v[176:179], a[88:91], a[40:43], v[176:179]
    v_exp_f32_e64 v165, v165
    v_mfma_f32_16x16x32_bf16 v[184:187], a[88:91], a[44:47], v[184:187]
    s_waitcnt lgkmcnt(3)
    buffer_load_dwordx4 v211, s[4:7], s20 offen offset:2048 lds
    v_mfma_f32_16x16x32_bf16 v[172:175], a[92:95], a[36:39], v[172:175]
    ds_read_b128 a[108:111], v205 offset:10240
    v_cvt_pk_bf16_f32 v162, v164, v165
    v_mfma_f32_16x16x32_bf16 v[180:183], a[92:95], a[40:43], v[180:183]
    v_exp_f32 v166, v166
    v_mfma_f32_16x16x32_bf16 v[188:191], a[92:95], a[44:47], v[188:191]
    s_waitcnt lgkmcnt(3)
    buffer_load_dwordx4 v211, s[4:7], s20 offen offset:3072 lds
    v_mfma_f32_16x16x32_bf16 v[168:171], a[96:99], a[48:51], v[168:171]
    ds_read_b64_tr_b16 a[88:89], v214 offset:24576
    ds_read_b64_tr_b16 a[90:91], v214 offset:26624
    v_mfma_f32_16x16x32_bf16 v[176:179], a[96:99], a[52:55], v[176:179]
    s_add_u32 m0, s15, 20480
    v_exp_f32 v167, v167
    v_mfma_f32_16x16x32_bf16 v[184:187], a[96:99], a[56:59], v[184:187]
    s_waitcnt lgkmcnt(4)
    buffer_load_dwordx4 v212, s[4:7], s20 offen offset:0 lds
    v_mfma_f32_16x16x32_bf16 v[172:175], a[100:103], a[48:51], v[172:175]
    ds_read_b64_tr_b16 a[92:93], v215 offset:24576
    ds_read_b64_tr_b16 a[94:95], v215 offset:26624
    v_mfma_f32_16x16x32_bf16 v[180:183], a[100:103], a[52:55], v[180:183]
    buffer_load_dwordx4 v212, s[4:7], s20 offen offset:1024 lds
    v_mfma_f32_16x16x32_bf16 v[188:191], a[100:103], a[56:59], v[188:191]
    s_waitcnt lgkmcnt(5)
    s_mul_i32 s38, s13, 1296
    v_cvt_pk_bf16_f32 v163, v166, v167
    v_mfma_f32_16x16x32_bf16 v[168:171], a[104:107], a[60:63], v[168:171]
    ds_read_b64_tr_b16 a[96:97], v216 offset:24576
    ds_read_b64_tr_b16 a[98:99], v216 offset:26624
    v_mfma_f32_16x16x32_bf16 v[176:179], a[104:107], a[64:67], v[176:179]
    buffer_load_dwordx4 v212, s[4:7], s20 offen offset:2048 lds
    v_mfma_f32_16x16x32_bf16 v[184:187], a[104:107], a[68:71], v[184:187]
    s_waitcnt lgkmcnt(6)
    s_mul_i32 s39, s14, 48
    v_mfma_f32_16x16x32_bf16 v[172:175], a[108:111], a[60:63], v[172:175]
    ds_read_b64_tr_b16 a[100:101], v217 offset:24576
    ds_read_b64_tr_b16 a[102:103], v217 offset:26624
    v_mfma_f32_16x16x32_bf16 v[180:183], a[108:111], a[64:67], v[180:183]
    buffer_load_dwordx4 v212, s[4:7], s20 offen offset:3072 lds
    v_mfma_f32_16x16x32_bf16 v[188:191], a[108:111], a[68:71], v[188:191]
    s_waitcnt lgkmcnt(6)
    s_add_u32 s38, s38, s39
    v_mfma_f32_16x16x32_bf16 a[72:75], a[84:87], v[144:147], a[72:75]
    v_exp_f32 v168, v168
    v_mfma_f32_16x16x32_bf16 a[76:79], a[84:87], v[152:155], a[76:79]
    v_exp_f32 v169, v169
    v_mfma_f32_16x16x32_bf16 a[80:83], a[84:87], v[160:163], a[80:83]
    v_exp_f32_e64 v170, v170
    v_mfma_f32_16x16x32_bf16 v[0:3], a[88:91], v[144:147], v[0:3]
    ds_read_b64_tr_b16 a[104:105], v218 offset:24576
    ds_read_b64_tr_b16 a[106:107], v218 offset:26624
    v_mfma_f32_16x16x32_bf16 v[4:7], a[88:91], v[152:155], v[4:7]
    v_exp_f32 v171, v171
    v_mfma_f32_16x16x32_bf16 v[8:11], a[88:91], v[160:163], v[8:11]
    s_waitcnt lgkmcnt(6)
    s_lshl_b32 s38, s38, 3
    v_mfma_f32_16x16x32_bf16 v[12:15], a[92:95], v[144:147], v[12:15]
    ds_read_b64_tr_b16 a[108:109], v219 offset:24576
    ds_read_b64_tr_b16 a[110:111], v219 offset:26624
    v_mfma_f32_16x16x32_bf16 v[16:19], a[92:95], v[152:155], v[16:19]
    v_exp_f32 v172, v172
    v_mfma_f32_16x16x32_bf16 v[20:23], a[92:95], v[160:163], v[20:23]
    s_waitcnt lgkmcnt(6)
    buffer_load_dwordx4 a[180:183], v211, s[4:7], s33 offen offset:1024
    v_mfma_f32_16x16x32_bf16 v[24:27], a[96:99], v[144:147], v[24:27]
    ds_read_b64_tr_b16 a[88:89], v220 offset:24576
    ds_read_b64_tr_b16 a[90:91], v220 offset:26624
    v_mfma_f32_16x16x32_bf16 v[28:31], a[96:99], v[152:155], v[28:31]
    v_exp_f32 v173, v173
    v_mfma_f32_16x16x32_bf16 v[32:35], a[96:99], v[160:163], v[32:35]
    s_waitcnt lgkmcnt(6)
    s_add_u32 s30, s38, 4194304
    v_mfma_f32_16x16x32_bf16 v[36:39], a[100:103], v[144:147], v[36:39]
    ds_read_b64_tr_b16 a[92:93], v221 offset:24576
    ds_read_b64_tr_b16 a[94:95], v221 offset:26624
    v_mfma_f32_16x16x32_bf16 v[40:43], a[100:103], v[152:155], v[40:43]
    v_exp_f32_e64 v174, v174
    v_mfma_f32_16x16x32_bf16 v[44:47], a[100:103], v[160:163], v[44:47]
    s_waitcnt lgkmcnt(6)
    buffer_load_dwordx4 a[184:187], v211, s[4:7], s33 offen offset:2048
    v_mfma_f32_16x16x32_bf16 v[48:51], a[104:107], v[144:147], v[48:51]
    ds_read_b64_tr_b16 a[96:97], v222 offset:24576
    ds_read_b64_tr_b16 a[98:99], v222 offset:26624
    v_mfma_f32_16x16x32_bf16 v[52:55], a[104:107], v[152:155], v[52:55]
    v_exp_f32 v175, v175
    v_mfma_f32_16x16x32_bf16 v[56:59], a[104:107], v[160:163], v[56:59]
    s_waitcnt lgkmcnt(6)
    s_add_u32 s31, s38, 4194432
    v_mfma_f32_16x16x32_bf16 v[60:63], a[108:111], v[144:147], v[60:63]
    ds_read_b64_tr_b16 a[100:101], v223 offset:24576
    ds_read_b64_tr_b16 a[102:103], v223 offset:26624
    v_mfma_f32_16x16x32_bf16 v[64:67], a[108:111], v[152:155], v[64:67]
    v_exp_f32 v176, v176
    v_mfma_f32_16x16x32_bf16 v[68:71], a[108:111], v[160:163], v[68:71]
    s_waitcnt lgkmcnt(6)
    s_add_u32 s32, s38, 4194560
    v_cvt_pk_bf16_f32 v168, v168, v169
    v_mfma_f32_16x16x32_bf16 v[72:75], a[88:91], v[144:147], v[72:75]
    ds_read_b64_tr_b16 a[104:105], v224 offset:24576
    ds_read_b64_tr_b16 a[106:107], v224 offset:26624
    v_mfma_f32_16x16x32_bf16 v[76:79], a[88:91], v[152:155], v[76:79]
    v_exp_f32 v177, v177
    v_mfma_f32_16x16x32_bf16 v[80:83], a[88:91], v[160:163], v[80:83]
    s_waitcnt lgkmcnt(6)
    v_cvt_pk_bf16_f32 v169, v170, v171
    v_lshlrev_b32_e64 v248, 3, v242
    v_mfma_f32_16x16x32_bf16 v[84:87], a[92:95], v[144:147], v[84:87]
    ds_read_b64_tr_b16 a[108:109], v225 offset:24576
    ds_read_b64_tr_b16 a[110:111], v225 offset:26624
    v_mfma_f32_16x16x32_bf16 v[88:91], a[92:95], v[152:155], v[88:91]
    v_exp_f32 v178, v178
    v_mfma_f32_16x16x32_bf16 v[92:95], a[92:95], v[160:163], v[92:95]
    s_waitcnt lgkmcnt(6)
    s_add_u32 s38, s15, 12288
    v_cvt_pk_bf16_f32 v170, v172, v173
    v_mfma_f32_16x16x32_bf16 v[96:99], a[96:99], v[144:147], v[96:99]
    s_waitcnt vmcnt(10)
    ds_read_b128 a[88:91], v204 offset:12288
    v_mfma_f32_16x16x32_bf16 v[100:103], a[96:99], v[152:155], v[100:103]
    v_exp_f32 v179, v179
    v_mfma_f32_16x16x32_bf16 v[104:107], a[96:99], v[160:163], v[104:107]
    s_waitcnt lgkmcnt(5)
    v_cvt_pk_bf16_f32 v171, v174, v175
    v_add_u32 v213, s38, v248
    v_mfma_f32_16x16x32_bf16 v[108:111], a[100:103], v[144:147], v[108:111]
    ds_read_b128 a[92:95], v204 offset:14336
    v_mfma_f32_16x16x32_bf16 v[112:115], a[100:103], v[152:155], v[112:115]
    v_exp_f32 v180, v180
    v_mfma_f32_16x16x32_bf16 v[116:119], a[100:103], v[160:163], v[116:119]
    s_waitcnt lgkmcnt(4)
    buffer_load_dwordx4 a[188:191], v211, s[4:7], s33 offen offset:3072
    v_mfma_f32_16x16x32_bf16 v[120:123], a[104:107], v[144:147], v[120:123]
    ds_read_b128 a[96:99], v205 offset:12288
    v_mfma_f32_16x16x32_bf16 v[124:127], a[104:107], v[152:155], v[124:127]
    v_exp_f32 v181, v181
    v_mfma_f32_16x16x32_bf16 v[128:131], a[104:107], v[160:163], v[128:131]
    s_waitcnt lgkmcnt(3)
    buffer_load_dwordx4 a[192:195], v212, s[4:7], s33 offen offset:0
    v_mfma_f32_16x16x32_bf16 v[132:135], a[108:111], v[144:147], v[132:135]
    ds_read_b128 a[100:103], v205 offset:14336
    v_mfma_f32_16x16x32_bf16 v[136:139], a[108:111], v[152:155], v[136:139]
    v_exp_f32 v182, v182
    v_mfma_f32_16x16x32_bf16 v[140:143], a[108:111], v[160:163], v[140:143]
    s_waitcnt lgkmcnt(3)
    v_lshrrev_b32 v248, 2, v243
    v_cmp_eq_u32 vcc, v248, v244
    v_mfma_f32_16x16x32_bf16 v[144:147], a[88:91], a[0:3], v[192:195]
    s_waitcnt vmcnt(8)
    ds_read_b128 a[104:107], v204 offset:16384
    v_mfma_f32_16x16x32_bf16 v[152:155], a[88:91], a[4:7], v[196:199]
    s_add_u32 m0, s15, 24576
    v_exp_f32_e64 v183, v183
    v_mfma_f32_16x16x32_bf16 v[160:163], a[88:91], a[8:11], v[200:203]
    s_waitcnt lgkmcnt(3)
    buffer_load_dwordx4 v210, s[4:7], s21 offen offset:0 lds
    v_mfma_f32_16x16x32_bf16 v[148:151], a[92:95], a[0:3], v[192:195]
    ds_read_b128 a[108:111], v204 offset:18432
    v_cvt_pk_bf16_f32 v176, v176, v177
    v_mfma_f32_16x16x32_bf16 v[156:159], a[92:95], a[4:7], v[196:199]
    v_exp_f32 v184, v184
    v_mfma_f32_16x16x32_bf16 v[164:167], a[92:95], a[8:11], v[200:203]
    s_waitcnt lgkmcnt(3)
    buffer_load_dwordx4 v210, s[4:7], s21 offen offset:1024 lds
    v_mfma_f32_16x16x32_bf16 v[144:147], a[96:99], a[12:15], v[144:147]
    ds_read_b128 a[88:91], v205 offset:16384
    v_cvt_pk_bf16_f32 v177, v178, v179
    v_mfma_f32_16x16x32_bf16 v[152:155], a[96:99], a[16:19], v[152:155]
    v_exp_f32 v185, v185
    v_mfma_f32_16x16x32_bf16 v[160:163], a[96:99], a[20:23], v[160:163]
    s_waitcnt lgkmcnt(3)
    buffer_load_dwordx4 v210, s[4:7], s21 offen offset:2048 lds
    v_mfma_f32_16x16x32_bf16 v[148:151], a[100:103], a[12:15], v[148:151]
    ds_read_b128 a[92:95], v205 offset:18432
    v_cvt_pk_bf16_f32 v178, v180, v181
    v_mfma_f32_16x16x32_bf16 v[156:159], a[100:103], a[16:19], v[156:159]
    v_exp_f32_e64 v186, v186
    v_mfma_f32_16x16x32_bf16 v[164:167], a[100:103], a[20:23], v[164:167]
    s_waitcnt lgkmcnt(3)
    buffer_load_dwordx4 v210, s[4:7], s21 offen offset:3072 lds
    v_mfma_f32_16x16x32_bf16 v[144:147], a[104:107], a[24:27], v[144:147]
    s_waitcnt vmcnt(8)
    ds_read_b128 a[96:99], v204 offset:20480
    v_cvt_pk_bf16_f32 v179, v182, v183
    v_mfma_f32_16x16x32_bf16 v[152:155], a[104:107], a[28:31], v[152:155]
    s_add_u32 m0, s15, 28672
    v_exp_f32 v187, v187
    v_mfma_f32_16x16x32_bf16 v[160:163], a[104:107], a[32:35], v[160:163]
    s_waitcnt lgkmcnt(3)
    buffer_load_dwordx4 v211, s[4:7], s21 offen offset:0 lds
    v_mfma_f32_16x16x32_bf16 v[148:151], a[108:111], a[24:27], v[148:151]
    ds_read_b128 a[100:103], v204 offset:22528
    v_cvt_pk_bf16_f32 v184, v184, v185
    v_mfma_f32_16x16x32_bf16 v[156:159], a[108:111], a[28:31], v[156:159]
    v_exp_f32 v188, v188
    v_mfma_f32_16x16x32_bf16 v[164:167], a[108:111], a[32:35], v[164:167]
    s_waitcnt lgkmcnt(3)
    buffer_load_dwordx4 v211, s[4:7], s21 offen offset:1024 lds
    v_mfma_f32_16x16x32_bf16 v[144:147], a[88:91], a[36:39], v[144:147]
    ds_read_b128 a[104:107], v205 offset:20480
    v_cvt_pk_bf16_f32 v185, v186, v187
    v_mfma_f32_16x16x32_bf16 v[152:155], a[88:91], a[40:43], v[152:155]
    v_exp_f32 v189, v189
    v_mfma_f32_16x16x32_bf16 v[160:163], a[88:91], a[44:47], v[160:163]
    s_waitcnt lgkmcnt(3)
    buffer_load_dwordx4 v211, s[4:7], s21 offen offset:2048 lds
    v_mfma_f32_16x16x32_bf16 v[148:151], a[92:95], a[36:39], v[148:151]
    ds_read_b128 a[108:111], v205 offset:22528
    v_cvt_pk_bf16_f32 v186, v188, v189
    v_mfma_f32_16x16x32_bf16 v[156:159], a[92:95], a[40:43], v[156:159]
    v_exp_f32 v190, v190
    v_mfma_f32_16x16x32_bf16 v[164:167], a[92:95], a[44:47], v[164:167]
    s_waitcnt lgkmcnt(3)
    buffer_load_dwordx4 v211, s[4:7], s21 offen offset:3072 lds
    v_mfma_f32_16x16x32_bf16 v[144:147], a[96:99], a[48:51], v[144:147]
    ds_read_b64_tr_b16 a[88:89], v214 offset:0
    ds_read_b64_tr_b16 a[90:91], v214 offset:2048
    v_mfma_f32_16x16x32_bf16 v[152:155], a[96:99], a[52:55], v[152:155]
    s_add_u32 m0, s15, 32768
    v_exp_f32 v191, v191
    v_mfma_f32_16x16x32_bf16 v[160:163], a[96:99], a[56:59], v[160:163]
    s_waitcnt lgkmcnt(4)
    buffer_load_dwordx4 v212, s[4:7], s21 offen offset:0 lds
    v_mfma_f32_16x16x32_bf16 v[148:151], a[100:103], a[48:51], v[148:151]
    ds_read_b64_tr_b16 a[92:93], v215 offset:0
    ds_read_b64_tr_b16 a[94:95], v215 offset:2048
    v_mfma_f32_16x16x32_bf16 v[156:159], a[100:103], a[52:55], v[156:159]
    buffer_load_dwordx4 v212, s[4:7], s21 offen offset:1024 lds
    v_mfma_f32_16x16x32_bf16 v[164:167], a[100:103], a[56:59], v[164:167]
    s_waitcnt lgkmcnt(5)
    v_cvt_pk_bf16_f32 v187, v190, v191
    v_and_b32 v249, 1, v243
    v_mfma_f32_16x16x32_bf16 v[144:147], a[104:107], a[60:63], v[144:147]
    ds_read_b64_tr_b16 a[96:97], v216 offset:0
    ds_read_b64_tr_b16 a[98:99], v216 offset:2048
    v_mfma_f32_16x16x32_bf16 v[152:155], a[104:107], a[64:67], v[152:155]
    buffer_load_dwordx4 v212, s[4:7], s21 offen offset:2048 lds
    v_mfma_f32_16x16x32_bf16 v[160:163], a[104:107], a[68:71], v[160:163]
    s_waitcnt lgkmcnt(6)
    v_mov_b32 v250, 0x3f80
    v_lshlrev_b32 v249, 4, v249
    v_mfma_f32_16x16x32_bf16 v[148:151], a[108:111], a[60:63], v[148:151]
    ds_read_b64_tr_b16 a[100:101], v217 offset:0
    ds_read_b64_tr_b16 a[102:103], v217 offset:2048
    v_mfma_f32_16x16x32_bf16 v[156:159], a[108:111], a[64:67], v[156:159]
    buffer_load_dwordx4 v212, s[4:7], s21 offen offset:3072 lds
    v_mfma_f32_16x16x32_bf16 v[164:167], a[108:111], a[68:71], v[164:167]
    s_waitcnt lgkmcnt(6)
    v_lshlrev_b32 v250, v249, v250
    v_cndmask_b32 v250, 0, v250, vcc
    v_mfma_f32_16x16x32_bf16 a[72:75], a[84:87], v[168:171], a[72:75]
    v_exp_f32 v144, v144
    v_mfma_f32_16x16x32_bf16 a[76:79], a[84:87], v[176:179], a[76:79]
    v_exp_f32 v145, v145
    v_mfma_f32_16x16x32_bf16 a[80:83], a[84:87], v[184:187], a[80:83]
    v_exp_f32 v146, v146
    v_mfma_f32_16x16x32_bf16 v[0:3], a[88:91], v[168:171], v[0:3]
    ds_read_b64_tr_b16 a[104:105], v218 offset:0
    ds_read_b64_tr_b16 a[106:107], v218 offset:2048
    v_mfma_f32_16x16x32_bf16 v[4:7], a[88:91], v[176:179], v[4:7]
    v_exp_f32 v147, v147
    v_mfma_f32_16x16x32_bf16 v[8:11], a[88:91], v[184:187], v[8:11]
    s_waitcnt lgkmcnt(6)
    v_and_b32 v249, 2, v243
    v_cmp_eq_u32 vcc, 0, v249
    v_mfma_f32_16x16x32_bf16 v[12:15], a[92:95], v[168:171], v[12:15]
    ds_read_b64_tr_b16 a[108:109], v219 offset:0
    ds_read_b64_tr_b16 a[110:111], v219 offset:2048
    v_mfma_f32_16x16x32_bf16 v[16:19], a[92:95], v[176:179], v[16:19]
    v_exp_f32 v148, v148
    v_mfma_f32_16x16x32_bf16 v[20:23], a[92:95], v[184:187], v[20:23]
    s_waitcnt lgkmcnt(6)
    buffer_load_dwordx4 a[196:199], v212, s[4:7], s33 offen offset:1024
    v_mfma_f32_16x16x32_bf16 v[24:27], a[96:99], v[168:171], v[24:27]
    ds_read_b64_tr_b16 a[88:89], v220 offset:0
    ds_read_b64_tr_b16 a[90:91], v220 offset:2048
    v_mfma_f32_16x16x32_bf16 v[28:31], a[96:99], v[176:179], v[28:31]
    v_exp_f32 v149, v149
    v_mfma_f32_16x16x32_bf16 v[32:35], a[96:99], v[184:187], v[32:35]
    s_waitcnt lgkmcnt(6)
    v_cndmask_b32 v248, 0, v250, vcc
    v_cmp_ne_u32 vcc, 0, v249
    v_mfma_f32_16x16x32_bf16 v[36:39], a[100:103], v[168:171], v[36:39]
    ds_read_b64_tr_b16 a[92:93], v221 offset:0
    ds_read_b64_tr_b16 a[94:95], v221 offset:2048
    v_mfma_f32_16x16x32_bf16 v[40:43], a[100:103], v[176:179], v[40:43]
    v_exp_f32 v150, v150
    v_mfma_f32_16x16x32_bf16 v[44:47], a[100:103], v[184:187], v[44:47]
    s_waitcnt lgkmcnt(6)
    buffer_load_dwordx4 a[200:203], v212, s[4:7], s33 offen offset:2048
    v_mfma_f32_16x16x32_bf16 v[48:51], a[104:107], v[168:171], v[48:51]
    ds_read_b64_tr_b16 a[96:97], v222 offset:0
    ds_read_b64_tr_b16 a[98:99], v222 offset:2048
    v_mfma_f32_16x16x32_bf16 v[52:55], a[104:107], v[176:179], v[52:55]
    v_exp_f32 v151, v151
    v_mfma_f32_16x16x32_bf16 v[56:59], a[104:107], v[184:187], v[56:59]
    s_waitcnt lgkmcnt(6)
    v_cndmask_b32 v249, 0, v250, vcc
    v_accvgpr_write_b32 a232, v248
    v_mfma_f32_16x16x32_bf16 v[60:63], a[108:111], v[168:171], v[60:63]
    ds_read_b64_tr_b16 a[100:101], v223 offset:0
    ds_read_b64_tr_b16 a[102:103], v223 offset:2048
    v_mfma_f32_16x16x32_bf16 v[64:67], a[108:111], v[176:179], v[64:67]
    v_exp_f32 v152, v152
    v_mfma_f32_16x16x32_bf16 v[68:71], a[108:111], v[184:187], v[68:71]
    s_waitcnt lgkmcnt(6)
    v_cvt_pk_bf16_f32 v144, v144, v145
    v_accvgpr_write_b32 a233, v249
    v_mfma_f32_16x16x32_bf16 v[72:75], a[88:91], v[168:171], v[72:75]
    ds_read_b64_tr_b16 a[104:105], v224 offset:0
    ds_read_b64_tr_b16 a[106:107], v224 offset:2048
    v_mfma_f32_16x16x32_bf16 v[76:79], a[88:91], v[176:179], v[76:79]
    v_exp_f32 v153, v153
    v_mfma_f32_16x16x32_bf16 v[80:83], a[88:91], v[184:187], v[80:83]
    s_waitcnt lgkmcnt(6)
    v_cvt_pk_bf16_f32 v145, v146, v147
    v_accvgpr_write_b32 a234, v248
    v_mfma_f32_16x16x32_bf16 v[84:87], a[92:95], v[168:171], v[84:87]
    ds_read_b64_tr_b16 a[108:109], v225 offset:0
    ds_read_b64_tr_b16 a[110:111], v225 offset:2048
    v_mfma_f32_16x16x32_bf16 v[88:91], a[92:95], v[176:179], v[88:91]
    v_exp_f32 v154, v154
    v_mfma_f32_16x16x32_bf16 v[92:95], a[92:95], v[184:187], v[92:95]
    s_waitcnt lgkmcnt(6)
    v_cvt_pk_bf16_f32 v146, v148, v149
    v_accvgpr_write_b32 a235, v249
    v_mfma_f32_16x16x32_bf16 v[96:99], a[96:99], v[168:171], v[96:99]
    s_waitcnt vmcnt(10)
    ds_read_b128 a[88:91], v204 offset:24576
    v_mfma_f32_16x16x32_bf16 v[100:103], a[96:99], v[176:179], v[100:103]
    v_exp_f32_e64 v155, v155
    v_mfma_f32_16x16x32_bf16 v[104:107], a[96:99], v[184:187], v[104:107]
    s_waitcnt lgkmcnt(5)
    v_cvt_pk_bf16_f32 v147, v150, v151
    v_lshlrev_b32 v248, 4, v243
    v_mfma_f32_16x16x32_bf16 v[108:111], a[100:103], v[168:171], v[108:111]
    ds_read_b128 a[92:95], v204 offset:26624
    v_mfma_f32_16x16x32_bf16 v[112:115], a[100:103], v[176:179], v[112:115]
    v_exp_f32 v156, v156
    v_mfma_f32_16x16x32_bf16 v[116:119], a[100:103], v[184:187], v[116:119]
    s_waitcnt lgkmcnt(4)
    buffer_load_dwordx4 a[204:207], v212, s[4:7], s33 offen offset:3072
    v_mfma_f32_16x16x32_bf16 v[120:123], a[104:107], v[168:171], v[120:123]
    ds_read_b128 a[96:99], v205 offset:24576
    v_mfma_f32_16x16x32_bf16 v[124:127], a[104:107], v[176:179], v[124:127]
    v_exp_f32 v157, v157
    v_mfma_f32_16x16x32_bf16 v[128:131], a[104:107], v[184:187], v[128:131]
    s_waitcnt lgkmcnt(3)
    buffer_load_dwordx4 a[208:211], v210, s[4:7], s34 offen offset:0
    v_mfma_f32_16x16x32_bf16 v[132:135], a[108:111], v[168:171], v[132:135]
    ds_read_b128 a[100:103], v205 offset:26624
    v_mfma_f32_16x16x32_bf16 v[136:139], a[108:111], v[176:179], v[136:139]
    v_exp_f32_e64 v158, v158
    v_mfma_f32_16x16x32_bf16 v[140:143], a[108:111], v[184:187], v[140:143]
    s_waitcnt lgkmcnt(3)
    v_add_u32 v248, 159744, v248
    v_mfma_f32_16x16x32_bf16 v[168:171], a[88:91], a[0:3], v[192:195]
    s_waitcnt vmcnt(8)
    ds_read_b128 a[104:107], v204 offset:28672
    v_mfma_f32_16x16x32_bf16 v[176:179], a[88:91], a[4:7], v[196:199]
    s_add_u32 m0, s15, 0
    v_exp_f32_e64 v159, v159
    v_mfma_f32_16x16x32_bf16 v[184:187], a[88:91], a[8:11], v[200:203]
    s_waitcnt lgkmcnt(3)
    buffer_load_dwordx4 v210, s[4:7], s22 offen offset:0 lds
    v_mfma_f32_16x16x32_bf16 v[172:175], a[92:95], a[0:3], v[192:195]
    ds_read_b128 a[108:111], v204 offset:30720
    v_cvt_pk_bf16_f32 v152, v152, v153
    v_mfma_f32_16x16x32_bf16 v[180:183], a[92:95], a[4:7], v[196:199]
    v_exp_f32 v160, v160
    v_mfma_f32_16x16x32_bf16 v[188:191], a[92:95], a[8:11], v[200:203]
    s_waitcnt lgkmcnt(3)
    buffer_load_dwordx4 v210, s[4:7], s22 offen offset:1024 lds
    v_mfma_f32_16x16x32_bf16 v[168:171], a[96:99], a[12:15], v[168:171]
    ds_read_b128 a[88:91], v205 offset:28672
    v_cvt_pk_bf16_f32 v153, v154, v155
    v_mfma_f32_16x16x32_bf16 v[176:179], a[96:99], a[16:19], v[176:179]
    v_exp_f32 v161, v161
    v_mfma_f32_16x16x32_bf16 v[184:187], a[96:99], a[20:23], v[184:187]
    s_waitcnt lgkmcnt(3)
    buffer_load_dwordx4 v210, s[4:7], s22 offen offset:2048 lds
    v_mfma_f32_16x16x32_bf16 v[172:175], a[100:103], a[12:15], v[172:175]
    ds_read_b128 a[92:95], v205 offset:30720
    v_cvt_pk_bf16_f32 v154, v156, v157
    v_mfma_f32_16x16x32_bf16 v[180:183], a[100:103], a[16:19], v[180:183]
    v_exp_f32_e64 v162, v162
    v_mfma_f32_16x16x32_bf16 v[188:191], a[100:103], a[20:23], v[188:191]
    s_waitcnt lgkmcnt(3)
    buffer_load_dwordx4 v210, s[4:7], s22 offen offset:3072 lds
    v_mfma_f32_16x16x32_bf16 v[168:171], a[104:107], a[24:27], v[168:171]
    s_waitcnt vmcnt(8)
    ds_read_b128 a[96:99], v204 offset:32768
    v_cvt_pk_bf16_f32 v155, v158, v159
    v_mfma_f32_16x16x32_bf16 v[176:179], a[104:107], a[28:31], v[176:179]
    s_add_u32 m0, s15, 4096
    v_exp_f32 v163, v163
    v_mfma_f32_16x16x32_bf16 v[184:187], a[104:107], a[32:35], v[184:187]
    s_waitcnt lgkmcnt(3)
    buffer_load_dwordx4 v211, s[4:7], s22 offen offset:0 lds
    v_mfma_f32_16x16x32_bf16 v[172:175], a[108:111], a[24:27], v[172:175]
    ds_read_b128 a[100:103], v204 offset:34816
    v_cvt_pk_bf16_f32 v160, v160, v161
    v_mfma_f32_16x16x32_bf16 v[180:183], a[108:111], a[28:31], v[180:183]
    v_exp_f32_e64 v164, v164
    v_mfma_f32_16x16x32_bf16 v[188:191], a[108:111], a[32:35], v[188:191]
    s_waitcnt lgkmcnt(3)
    buffer_load_dwordx4 v211, s[4:7], s22 offen offset:1024 lds
    v_mfma_f32_16x16x32_bf16 v[168:171], a[88:91], a[36:39], v[168:171]
    ds_read_b128 a[104:107], v205 offset:32768
    v_cvt_pk_bf16_f32 v161, v162, v163
    v_mfma_f32_16x16x32_bf16 v[176:179], a[88:91], a[40:43], v[176:179]
    v_exp_f32 v165, v165
    v_mfma_f32_16x16x32_bf16 v[184:187], a[88:91], a[44:47], v[184:187]
    s_waitcnt lgkmcnt(3)
    buffer_load_dwordx4 v211, s[4:7], s22 offen offset:2048 lds
    v_mfma_f32_16x16x32_bf16 v[172:175], a[92:95], a[36:39], v[172:175]
    ds_read_b128 a[108:111], v205 offset:34816
    v_cvt_pk_bf16_f32 v162, v164, v165
    v_mfma_f32_16x16x32_bf16 v[180:183], a[92:95], a[40:43], v[180:183]
    v_exp_f32_e64 v166, v166
    v_mfma_f32_16x16x32_bf16 v[188:191], a[92:95], a[44:47], v[188:191]
    s_waitcnt lgkmcnt(3)
    buffer_load_dwordx4 v211, s[4:7], s22 offen offset:3072 lds
    v_mfma_f32_16x16x32_bf16 v[168:171], a[96:99], a[48:51], v[168:171]
    ds_read_b64_tr_b16 a[88:89], v214 offset:12288
    ds_read_b64_tr_b16 a[90:91], v214 offset:14336
    v_mfma_f32_16x16x32_bf16 v[176:179], a[96:99], a[52:55], v[176:179]
    s_add_u32 m0, s15, 8192
    v_exp_f32 v167, v167
    v_mfma_f32_16x16x32_bf16 v[184:187], a[96:99], a[56:59], v[184:187]
    s_waitcnt lgkmcnt(4)
    buffer_load_dwordx4 v212, s[4:7], s22 offen offset:0 lds
    v_mfma_f32_16x16x32_bf16 v[172:175], a[100:103], a[48:51], v[172:175]
    ds_read_b64_tr_b16 a[92:93], v215 offset:12288
    ds_read_b64_tr_b16 a[94:95], v215 offset:14336
    v_mfma_f32_16x16x32_bf16 v[180:183], a[100:103], a[52:55], v[180:183]
    buffer_load_dwordx4 v212, s[4:7], s22 offen offset:1024 lds
    v_mfma_f32_16x16x32_bf16 v[188:191], a[100:103], a[56:59], v[188:191]
    s_waitcnt lgkmcnt(5)
    s_lshl_b32 s40, s12, 2
    v_cvt_pk_bf16_f32 v163, v166, v167
    v_mfma_f32_16x16x32_bf16 v[168:171], a[104:107], a[60:63], v[168:171]
    ds_read_b64_tr_b16 a[96:97], v216 offset:12288
    ds_read_b64_tr_b16 a[98:99], v216 offset:14336
    v_mfma_f32_16x16x32_bf16 v[176:179], a[104:107], a[64:67], v[176:179]
    buffer_load_dwordx4 v212, s[4:7], s22 offen offset:2048 lds
    v_mfma_f32_16x16x32_bf16 v[184:187], a[104:107], a[68:71], v[184:187]
    s_waitcnt lgkmcnt(6)
    v_add_u32 v249, s40, v248
    v_lshlrev_b32_e64 v250, 3, v242
    v_mfma_f32_16x16x32_bf16 v[172:175], a[108:111], a[60:63], v[172:175]
    ds_read_b64_tr_b16 a[100:101], v217 offset:12288
    ds_read_b64_tr_b16 a[102:103], v217 offset:14336
    v_mfma_f32_16x16x32_bf16 v[180:183], a[108:111], a[64:67], v[180:183]
    buffer_load_dwordx4 v212, s[4:7], s22 offen offset:3072 lds
    v_mfma_f32_16x16x32_bf16 v[188:191], a[108:111], a[68:71], v[188:191]
    s_waitcnt lgkmcnt(6)
    s_add_u32 s40, s12, 3
    v_mfma_f32_16x16x32_bf16 a[72:75], a[84:87], v[144:147], a[72:75]
    v_exp_f32 v168, v168
    v_mfma_f32_16x16x32_bf16 a[76:79], a[84:87], v[152:155], a[76:79]
    v_exp_f32 v169, v169
    v_mfma_f32_16x16x32_bf16 a[80:83], a[84:87], v[160:163], a[80:83]
    v_exp_f32_e64 v170, v170
    v_mfma_f32_16x16x32_bf16 v[0:3], a[88:91], v[144:147], v[0:3]
    ds_read_b64_tr_b16 a[104:105], v218 offset:12288
    ds_read_b64_tr_b16 a[106:107], v218 offset:14336
    v_mfma_f32_16x16x32_bf16 v[4:7], a[88:91], v[152:155], v[4:7]
    v_exp_f32 v171, v171
    v_mfma_f32_16x16x32_bf16 v[8:11], a[88:91], v[160:163], v[8:11]
    s_waitcnt lgkmcnt(6)
    s_and_b32 s40, s40, 3
    v_mfma_f32_16x16x32_bf16 v[12:15], a[92:95], v[144:147], v[12:15]
    ds_read_b64_tr_b16 a[108:109], v219 offset:12288
    ds_read_b64_tr_b16 a[110:111], v219 offset:14336
    v_mfma_f32_16x16x32_bf16 v[16:19], a[92:95], v[152:155], v[16:19]
    v_exp_f32 v172, v172
    v_mfma_f32_16x16x32_bf16 v[20:23], a[92:95], v[160:163], v[20:23]
    s_waitcnt lgkmcnt(6)
    buffer_load_dwordx4 a[212:215], v210, s[4:7], s34 offen offset:1024
    v_mfma_f32_16x16x32_bf16 v[24:27], a[96:99], v[144:147], v[24:27]
    ds_read_b64_tr_b16 a[88:89], v220 offset:12288
    ds_read_b64_tr_b16 a[90:91], v220 offset:14336
    v_mfma_f32_16x16x32_bf16 v[28:31], a[96:99], v[152:155], v[28:31]
    v_exp_f32 v173, v173
    v_mfma_f32_16x16x32_bf16 v[32:35], a[96:99], v[160:163], v[32:35]
    s_waitcnt lgkmcnt(6)
    s_mul_i32 s40, s40, 36864
    v_mfma_f32_16x16x32_bf16 v[36:39], a[100:103], v[144:147], v[36:39]
    ds_read_b64_tr_b16 a[92:93], v221 offset:12288
    ds_read_b64_tr_b16 a[94:95], v221 offset:14336
    v_mfma_f32_16x16x32_bf16 v[40:43], a[100:103], v[152:155], v[40:43]
    v_exp_f32_e64 v174, v174
    v_mfma_f32_16x16x32_bf16 v[44:47], a[100:103], v[160:163], v[44:47]
    s_waitcnt lgkmcnt(6)
    buffer_load_dwordx4 a[216:219], v210, s[4:7], s34 offen offset:2048
    v_mfma_f32_16x16x32_bf16 v[48:51], a[104:107], v[144:147], v[48:51]
    ds_read_b64_tr_b16 a[96:97], v222 offset:12288
    ds_read_b64_tr_b16 a[98:99], v222 offset:14336
    v_mfma_f32_16x16x32_bf16 v[52:55], a[104:107], v[152:155], v[52:55]
    v_exp_f32 v175, v175
    v_mfma_f32_16x16x32_bf16 v[56:59], a[104:107], v[160:163], v[56:59]
    s_waitcnt lgkmcnt(6)
    s_add_u32 s40, s40, 12288
    v_add_u32 v226, s40, v250
    v_mfma_f32_16x16x32_bf16 v[60:63], a[108:111], v[144:147], v[60:63]
    ds_read_b64_tr_b16 a[100:101], v223 offset:12288
    ds_read_b64_tr_b16 a[102:103], v223 offset:14336
    v_mfma_f32_16x16x32_bf16 v[64:67], a[108:111], v[152:155], v[64:67]
    v_exp_f32 v176, v176
    v_mfma_f32_16x16x32_bf16 v[68:71], a[108:111], v[160:163], v[68:71]
    s_waitcnt lgkmcnt(6)
    s_add_u32 s40, s12, 2
    v_cvt_pk_bf16_f32 v168, v168, v169
    v_mfma_f32_16x16x32_bf16 v[72:75], a[88:91], v[144:147], v[72:75]
    ds_read_b64_tr_b16 a[104:105], v224 offset:12288
    ds_read_b64_tr_b16 a[106:107], v224 offset:14336
    v_mfma_f32_16x16x32_bf16 v[76:79], a[88:91], v[152:155], v[76:79]
    v_exp_f32_e64 v177, v177
    v_mfma_f32_16x16x32_bf16 v[80:83], a[88:91], v[160:163], v[80:83]
    s_waitcnt lgkmcnt(6)
    s_and_b32 s40, s40, 3
    v_cvt_pk_bf16_f32 v169, v170, v171
    v_mfma_f32_16x16x32_bf16 v[84:87], a[92:95], v[144:147], v[84:87]
    ds_read_b64_tr_b16 a[108:109], v225 offset:12288
    ds_read_b64_tr_b16 a[110:111], v225 offset:14336
    v_mfma_f32_16x16x32_bf16 v[88:91], a[92:95], v[152:155], v[88:91]
    v_exp_f32 v178, v178
    v_mfma_f32_16x16x32_bf16 v[92:95], a[92:95], v[160:163], v[92:95]
    s_waitcnt lgkmcnt(6)
    s_mul_i32 s40, s40, 36864
    v_cvt_pk_bf16_f32 v170, v172, v173
    v_mfma_f32_16x16x32_bf16 v[96:99], a[96:99], v[144:147], v[96:99]
    s_waitcnt vmcnt(10)
    ds_read_b128 a[88:91], v204 offset:0
    v_mfma_f32_16x16x32_bf16 v[100:103], a[96:99], v[152:155], v[100:103]
    v_exp_f32_e64 v179, v179
    v_mfma_f32_16x16x32_bf16 v[104:107], a[96:99], v[160:163], v[104:107]
    s_waitcnt lgkmcnt(5)
    s_add_u32 s40, s40, 16896
    v_cvt_pk_bf16_f32 v171, v174, v175
    v_mfma_f32_16x16x32_bf16 v[108:111], a[100:103], v[144:147], v[108:111]
    ds_read_b128 a[92:95], v204 offset:2048
    v_mfma_f32_16x16x32_bf16 v[112:115], a[100:103], v[152:155], v[112:115]
    v_exp_f32 v180, v180
    v_mfma_f32_16x16x32_bf16 v[116:119], a[100:103], v[160:163], v[116:119]
    s_waitcnt lgkmcnt(4)
    buffer_load_dwordx4 a[220:223], v210, s[4:7], s34 offen offset:3072
    v_mfma_f32_16x16x32_bf16 v[120:123], a[104:107], v[144:147], v[120:123]
    ds_read_b128 a[96:99], v205 offset:0
    v_mfma_f32_16x16x32_bf16 v[124:127], a[104:107], v[152:155], v[124:127]
    v_exp_f32 v181, v181
    v_mfma_f32_16x16x32_bf16 v[128:131], a[104:107], v[160:163], v[128:131]
    s_waitcnt lgkmcnt(3)
    buffer_load_dwordx4 a[224:227], v211, s[4:7], s34 offen offset:0
    v_mfma_f32_16x16x32_bf16 v[132:135], a[108:111], v[144:147], v[132:135]
    ds_read_b128 a[100:103], v205 offset:2048
    v_mfma_f32_16x16x32_bf16 v[136:139], a[108:111], v[152:155], v[136:139]
    v_exp_f32_e64 v182, v182
    v_mfma_f32_16x16x32_bf16 v[140:143], a[108:111], v[160:163], v[140:143]
    s_waitcnt lgkmcnt(3)
    v_add_u32 v227, s40, v250
    v_mfma_f32_16x16x32_bf16 v[144:147], a[88:91], a[0:3], v[192:195]
    s_waitcnt vmcnt(8)
    ds_read_b128 a[104:107], v204 offset:4096
    v_mfma_f32_16x16x32_bf16 v[152:155], a[88:91], a[4:7], v[196:199]
    s_add_u32 m0, s15, 12288
    v_exp_f32 v183, v183
    v_mfma_f32_16x16x32_bf16 v[160:163], a[88:91], a[8:11], v[200:203]
    s_waitcnt lgkmcnt(3)
    buffer_load_dwordx4 v210, s[4:7], s23 offen offset:0 lds
    v_mfma_f32_16x16x32_bf16 v[148:151], a[92:95], a[0:3], v[192:195]
    ds_read_b128 a[108:111], v204 offset:6144
    v_cvt_pk_bf16_f32 v176, v176, v177
    v_mfma_f32_16x16x32_bf16 v[156:159], a[92:95], a[4:7], v[196:199]
    v_exp_f32_e64 v184, v184
    v_mfma_f32_16x16x32_bf16 v[164:167], a[92:95], a[8:11], v[200:203]
    s_waitcnt lgkmcnt(3)
    buffer_load_dwordx4 v210, s[4:7], s23 offen offset:1024 lds
    v_mfma_f32_16x16x32_bf16 v[144:147], a[96:99], a[12:15], v[144:147]
    ds_read_b128 a[88:91], v205 offset:4096
    v_cvt_pk_bf16_f32 v177, v178, v179
    v_mfma_f32_16x16x32_bf16 v[152:155], a[96:99], a[16:19], v[152:155]
    v_exp_f32 v185, v185
    v_mfma_f32_16x16x32_bf16 v[160:163], a[96:99], a[20:23], v[160:163]
    s_waitcnt lgkmcnt(3)
    buffer_load_dwordx4 v210, s[4:7], s23 offen offset:2048 lds
    v_mfma_f32_16x16x32_bf16 v[148:151], a[100:103], a[12:15], v[148:151]
    ds_read_b128 a[92:95], v205 offset:6144
    v_cvt_pk_bf16_f32 v178, v180, v181
    v_mfma_f32_16x16x32_bf16 v[156:159], a[100:103], a[16:19], v[156:159]
    v_exp_f32 v186, v186
    v_mfma_f32_16x16x32_bf16 v[164:167], a[100:103], a[20:23], v[164:167]
    s_waitcnt lgkmcnt(3)
    buffer_load_dwordx4 v210, s[4:7], s23 offen offset:3072 lds
    v_mfma_f32_16x16x32_bf16 v[144:147], a[104:107], a[24:27], v[144:147]
    s_waitcnt vmcnt(8)
    ds_read_b128 a[96:99], v204 offset:8192
    v_cvt_pk_bf16_f32 v179, v182, v183
    v_mfma_f32_16x16x32_bf16 v[152:155], a[104:107], a[28:31], v[152:155]
    s_add_u32 m0, s15, 16384
    v_exp_f32_e64 v187, v187
    v_mfma_f32_16x16x32_bf16 v[160:163], a[104:107], a[32:35], v[160:163]
    s_waitcnt lgkmcnt(3)
    buffer_load_dwordx4 v211, s[4:7], s23 offen offset:0 lds
    v_mfma_f32_16x16x32_bf16 v[148:151], a[108:111], a[24:27], v[148:151]
    ds_read_b128 a[100:103], v204 offset:10240
    v_cvt_pk_bf16_f32 v184, v184, v185
    v_mfma_f32_16x16x32_bf16 v[156:159], a[108:111], a[28:31], v[156:159]
    v_exp_f32 v188, v188
    v_mfma_f32_16x16x32_bf16 v[164:167], a[108:111], a[32:35], v[164:167]
    s_waitcnt lgkmcnt(3)
    buffer_load_dwordx4 v211, s[4:7], s23 offen offset:1024 lds
    v_mfma_f32_16x16x32_bf16 v[144:147], a[88:91], a[36:39], v[144:147]
    ds_read_b128 a[104:107], v205 offset:8192
    v_cvt_pk_bf16_f32 v185, v186, v187
    v_mfma_f32_16x16x32_bf16 v[152:155], a[88:91], a[40:43], v[152:155]
    v_exp_f32 v189, v189
    v_mfma_f32_16x16x32_bf16 v[160:163], a[88:91], a[44:47], v[160:163]
    s_waitcnt lgkmcnt(3)
    buffer_load_dwordx4 v211, s[4:7], s23 offen offset:2048 lds
    v_mfma_f32_16x16x32_bf16 v[148:151], a[92:95], a[36:39], v[148:151]
    ds_read_b128 a[108:111], v205 offset:10240
    v_cvt_pk_bf16_f32 v186, v188, v189
    v_mfma_f32_16x16x32_bf16 v[156:159], a[92:95], a[40:43], v[156:159]
    v_exp_f32 v190, v190
    v_mfma_f32_16x16x32_bf16 v[164:167], a[92:95], a[44:47], v[164:167]
    s_waitcnt lgkmcnt(3)
    buffer_load_dwordx4 v211, s[4:7], s23 offen offset:3072 lds
    v_mfma_f32_16x16x32_bf16 v[144:147], a[96:99], a[48:51], v[144:147]
    ds_read_b64_tr_b16 a[88:89], v214 offset:24576
    ds_read_b64_tr_b16 a[90:91], v214 offset:26624
    v_mfma_f32_16x16x32_bf16 v[152:155], a[96:99], a[52:55], v[152:155]
    s_add_u32 m0, s15, 20480
    v_exp_f32 v191, v191
    v_mfma_f32_16x16x32_bf16 v[160:163], a[96:99], a[56:59], v[160:163]
    s_waitcnt lgkmcnt(4)
    buffer_load_dwordx4 v212, s[4:7], s23 offen offset:0 lds
    v_mfma_f32_16x16x32_bf16 v[148:151], a[100:103], a[48:51], v[148:151]
    ds_read_b64_tr_b16 a[92:93], v215 offset:24576
    ds_read_b64_tr_b16 a[94:95], v215 offset:26624
    v_mfma_f32_16x16x32_bf16 v[156:159], a[100:103], a[52:55], v[156:159]
    buffer_load_dwordx4 v212, s[4:7], s23 offen offset:1024 lds
    v_mfma_f32_16x16x32_bf16 v[164:167], a[100:103], a[56:59], v[164:167]
    s_waitcnt lgkmcnt(5)
    s_add_u32 s40, s12, 1
    v_cvt_pk_bf16_f32 v187, v190, v191
    v_mfma_f32_16x16x32_bf16 v[144:147], a[104:107], a[60:63], v[144:147]
    ds_read_b64_tr_b16 a[96:97], v216 offset:24576
    ds_read_b64_tr_b16 a[98:99], v216 offset:26624
    v_mfma_f32_16x16x32_bf16 v[152:155], a[104:107], a[64:67], v[152:155]
    buffer_load_dwordx4 v212, s[4:7], s23 offen offset:2048 lds
    v_mfma_f32_16x16x32_bf16 v[160:163], a[104:107], a[68:71], v[160:163]
    s_waitcnt lgkmcnt(6)
    s_and_b32 s40, s40, 3
    v_mfma_f32_16x16x32_bf16 v[148:151], a[108:111], a[60:63], v[148:151]
    ds_read_b64_tr_b16 a[100:101], v217 offset:24576
    ds_read_b64_tr_b16 a[102:103], v217 offset:26624
    v_mfma_f32_16x16x32_bf16 v[156:159], a[108:111], a[64:67], v[156:159]
    buffer_load_dwordx4 v212, s[4:7], s23 offen offset:3072 lds
    v_mfma_f32_16x16x32_bf16 v[164:167], a[108:111], a[68:71], v[164:167]
    s_waitcnt lgkmcnt(6)
    s_mul_i32 s40, s40, 36864
    v_mfma_f32_16x16x32_bf16 a[72:75], a[84:87], v[168:171], a[72:75]
    v_exp_f32 v144, v144
    v_mfma_f32_16x16x32_bf16 a[76:79], a[84:87], v[176:179], a[76:79]
    v_exp_f32 v145, v145
    v_mfma_f32_16x16x32_bf16 a[80:83], a[84:87], v[184:187], a[80:83]
    v_exp_f32 v146, v146
    v_mfma_f32_16x16x32_bf16 v[0:3], a[88:91], v[168:171], v[0:3]
    ds_read_b64_tr_b16 a[104:105], v218 offset:24576
    ds_read_b64_tr_b16 a[106:107], v218 offset:26624
    v_mfma_f32_16x16x32_bf16 v[4:7], a[88:91], v[176:179], v[4:7]
    v_exp_f32 v147, v147
    v_mfma_f32_16x16x32_bf16 v[8:11], a[88:91], v[184:187], v[8:11]
    s_waitcnt lgkmcnt(6)
    s_add_u32 s40, s40, 21504
    v_add_u32_e64 v228, s40, v250
    v_mfma_f32_16x16x32_bf16 v[12:15], a[92:95], v[168:171], v[12:15]
    ds_read_b64_tr_b16 a[108:109], v219 offset:24576
    ds_read_b64_tr_b16 a[110:111], v219 offset:26624
    v_mfma_f32_16x16x32_bf16 v[16:19], a[92:95], v[176:179], v[16:19]
    v_exp_f32 v148, v148
    v_mfma_f32_16x16x32_bf16 v[20:23], a[92:95], v[184:187], v[20:23]
    s_waitcnt lgkmcnt(6)
    buffer_load_dwordx4 a[228:231], v211, s[4:7], s34 offen offset:1024
    v_mfma_f32_16x16x32_bf16 v[24:27], a[96:99], v[168:171], v[24:27]
    ds_read_b64_tr_b16 a[88:89], v220 offset:24576
    ds_read_b64_tr_b16 a[90:91], v220 offset:26624
    v_mfma_f32_16x16x32_bf16 v[28:31], a[96:99], v[176:179], v[28:31]
    v_exp_f32_e64 v149, v149
    v_mfma_f32_16x16x32_bf16 v[32:35], a[96:99], v[184:187], v[32:35]
    s_waitcnt lgkmcnt(6)
    s_mul_i32 s40, s12, 3
    v_mfma_f32_16x16x32_bf16 v[36:39], a[100:103], v[168:171], v[36:39]
    ds_read_b64_tr_b16 a[92:93], v221 offset:24576
    ds_read_b64_tr_b16 a[94:95], v221 offset:26624
    v_mfma_f32_16x16x32_bf16 v[40:43], a[100:103], v[176:179], v[40:43]
    v_exp_f32 v150, v150
    v_mfma_f32_16x16x32_bf16 v[44:47], a[100:103], v[184:187], v[44:47]
    s_waitcnt lgkmcnt(6)
    buffer_load_dwordx4 v[230:233], v245, s[4:7], s29 offen
    v_mfma_f32_16x16x32_bf16 v[48:51], a[104:107], v[168:171], v[48:51]
    ds_read_b64_tr_b16 a[96:97], v222 offset:24576
    ds_read_b64_tr_b16 a[98:99], v222 offset:26624
    v_mfma_f32_16x16x32_bf16 v[52:55], a[104:107], v[176:179], v[52:55]
    v_exp_f32 v151, v151
    v_mfma_f32_16x16x32_bf16 v[56:59], a[104:107], v[184:187], v[56:59]
    s_waitcnt lgkmcnt(6)
    s_add_u32 s40, s40, 0
    v_mfma_f32_16x16x32_bf16 v[60:63], a[108:111], v[168:171], v[60:63]
    ds_read_b64_tr_b16 a[100:101], v223 offset:24576
    ds_read_b64_tr_b16 a[102:103], v223 offset:26624
    v_mfma_f32_16x16x32_bf16 v[64:67], a[108:111], v[176:179], v[64:67]
    v_exp_f32 v152, v152
    v_mfma_f32_16x16x32_bf16 v[68:71], a[108:111], v[184:187], v[68:71]
    s_waitcnt lgkmcnt(6)
    s_lshr_b32 s41, s40, 1
    v_cvt_pk_bf16_f32 v144, v144, v145
    v_mfma_f32_16x16x32_bf16 v[72:75], a[88:91], v[168:171], v[72:75]
    ds_read_b64_tr_b16 a[104:105], v224 offset:24576
    ds_read_b64_tr_b16 a[106:107], v224 offset:26624
    v_mfma_f32_16x16x32_bf16 v[76:79], a[88:91], v[176:179], v[76:79]
    v_exp_f32_e64 v153, v153
    v_mfma_f32_16x16x32_bf16 v[80:83], a[88:91], v[184:187], v[80:83]
    s_waitcnt lgkmcnt(6)
    s_mul_i32 s41, s41, 3072
    v_cvt_pk_bf16_f32 v145, v146, v147
    v_mfma_f32_16x16x32_bf16 v[84:87], a[92:95], v[168:171], v[84:87]
    ds_read_b64_tr_b16 a[108:109], v225 offset:24576
    ds_read_b64_tr_b16 a[110:111], v225 offset:26624
    v_mfma_f32_16x16x32_bf16 v[88:91], a[92:95], v[176:179], v[88:91]
    v_exp_f32 v154, v154
    v_mfma_f32_16x16x32_bf16 v[92:95], a[92:95], v[184:187], v[92:95]
    s_waitcnt lgkmcnt(6)
    s_and_b32 s40, s40, 1
    v_cvt_pk_bf16_f32 v146, v148, v149
    v_mfma_f32_16x16x32_bf16 v[96:99], a[96:99], v[168:171], v[96:99]
    s_waitcnt vmcnt(10)
    ds_read_b128 a[88:91], v204 offset:12288
    v_mfma_f32_16x16x32_bf16 v[100:103], a[96:99], v[176:179], v[100:103]
    v_exp_f32 v155, v155
    v_mfma_f32_16x16x32_bf16 v[104:107], a[96:99], v[184:187], v[104:107]
    s_waitcnt lgkmcnt(5)
    s_lshl_b32 s40, s40, 3
    v_cvt_pk_bf16_f32 v147, v150, v151
    v_mfma_f32_16x16x32_bf16 v[108:111], a[100:103], v[168:171], v[108:111]
    ds_read_b128 a[92:95], v204 offset:14336
    v_mfma_f32_16x16x32_bf16 v[112:115], a[100:103], v[176:179], v[112:115]
    v_exp_f32 v156, v156
    v_mfma_f32_16x16x32_bf16 v[116:119], a[100:103], v[184:187], v[116:119]
    s_waitcnt lgkmcnt(4)
    buffer_load_dwordx2 v[234:235], v246, s[4:7], s29 offen
    v_mfma_f32_16x16x32_bf16 v[120:123], a[104:107], v[168:171], v[120:123]
    ds_read_b128 a[96:99], v205 offset:12288
    v_mfma_f32_16x16x32_bf16 v[124:127], a[104:107], v[176:179], v[124:127]
    v_exp_f32 v157, v157
    v_mfma_f32_16x16x32_bf16 v[128:131], a[104:107], v[184:187], v[128:131]
    s_waitcnt lgkmcnt(3)
    buffer_load_dwordx2 v[236:237], v247, s[4:7], s30 offen
    v_mfma_f32_16x16x32_bf16 v[132:135], a[108:111], v[168:171], v[132:135]
    ds_read_b128 a[100:103], v205 offset:14336
    v_mfma_f32_16x16x32_bf16 v[136:139], a[108:111], v[176:179], v[136:139]
    v_exp_f32 v158, v158
    v_mfma_f32_16x16x32_bf16 v[140:143], a[108:111], v[184:187], v[140:143]
    s_waitcnt lgkmcnt(3)
    s_add_u32 s40, s40, s41
    v_mfma_f32_16x16x32_bf16 v[168:171], a[88:91], a[0:3], v[192:195]
    s_waitcnt vmcnt(8)
    ds_read_b128 a[104:107], v204 offset:16384
    v_mfma_f32_16x16x32_bf16 v[176:179], a[88:91], a[4:7], v[196:199]
    s_add_u32 m0, s15, 24576
    v_exp_f32 v159, v159
    v_mfma_f32_16x16x32_bf16 v[184:187], a[88:91], a[8:11], v[200:203]
    s_waitcnt lgkmcnt(3)
    buffer_load_dwordx4 v210, s[4:7], s24 offen offset:0 lds
    v_mfma_f32_16x16x32_bf16 v[172:175], a[92:95], a[0:3], v[192:195]
    ds_read_b128 a[108:111], v204 offset:18432
    v_cvt_pk_bf16_f32 v152, v152, v153
    v_mfma_f32_16x16x32_bf16 v[180:183], a[92:95], a[4:7], v[196:199]
    v_exp_f32_e64 v160, v160
    v_mfma_f32_16x16x32_bf16 v[188:191], a[92:95], a[8:11], v[200:203]
    s_waitcnt lgkmcnt(3)
    buffer_load_dwordx4 v210, s[4:7], s24 offen offset:1024 lds
    v_mfma_f32_16x16x32_bf16 v[168:171], a[96:99], a[12:15], v[168:171]
    ds_read_b128 a[88:91], v205 offset:16384
    v_cvt_pk_bf16_f32 v153, v154, v155
    v_mfma_f32_16x16x32_bf16 v[176:179], a[96:99], a[16:19], v[176:179]
    v_exp_f32 v161, v161
    v_mfma_f32_16x16x32_bf16 v[184:187], a[96:99], a[20:23], v[184:187]
    s_waitcnt lgkmcnt(3)
    buffer_load_dwordx4 v210, s[4:7], s24 offen offset:2048 lds
    v_mfma_f32_16x16x32_bf16 v[172:175], a[100:103], a[12:15], v[172:175]
    ds_read_b128 a[92:95], v205 offset:18432
    v_cvt_pk_bf16_f32 v154, v156, v157
    v_mfma_f32_16x16x32_bf16 v[180:183], a[100:103], a[16:19], v[180:183]
    v_exp_f32_e64 v162, v162
    v_mfma_f32_16x16x32_bf16 v[188:191], a[100:103], a[20:23], v[188:191]
    s_waitcnt lgkmcnt(3)
    buffer_load_dwordx4 v210, s[4:7], s24 offen offset:3072 lds
    v_mfma_f32_16x16x32_bf16 v[168:171], a[104:107], a[24:27], v[168:171]
    s_waitcnt vmcnt(8)
    ds_read_b128 a[96:99], v204 offset:20480
    v_cvt_pk_bf16_f32 v155, v158, v159
    v_mfma_f32_16x16x32_bf16 v[176:179], a[104:107], a[28:31], v[176:179]
    s_add_u32 m0, s15, 28672
    v_exp_f32 v163, v163
    v_mfma_f32_16x16x32_bf16 v[184:187], a[104:107], a[32:35], v[184:187]
    s_waitcnt lgkmcnt(3)
    buffer_load_dwordx4 v211, s[4:7], s24 offen offset:0 lds
    v_mfma_f32_16x16x32_bf16 v[172:175], a[108:111], a[24:27], v[172:175]
    ds_read_b128 a[100:103], v204 offset:22528
    v_cvt_pk_bf16_f32 v160, v160, v161
    v_mfma_f32_16x16x32_bf16 v[180:183], a[108:111], a[28:31], v[180:183]
    v_exp_f32_e64 v164, v164
    v_mfma_f32_16x16x32_bf16 v[188:191], a[108:111], a[32:35], v[188:191]
    s_waitcnt lgkmcnt(3)
    buffer_load_dwordx4 v211, s[4:7], s24 offen offset:1024 lds
    v_mfma_f32_16x16x32_bf16 v[168:171], a[88:91], a[36:39], v[168:171]
    ds_read_b128 a[104:107], v205 offset:20480
    v_cvt_pk_bf16_f32 v161, v162, v163
    v_mfma_f32_16x16x32_bf16 v[176:179], a[88:91], a[40:43], v[176:179]
    v_exp_f32 v165, v165
    v_mfma_f32_16x16x32_bf16 v[184:187], a[88:91], a[44:47], v[184:187]
    s_waitcnt lgkmcnt(3)
    buffer_load_dwordx4 v211, s[4:7], s24 offen offset:2048 lds
    v_mfma_f32_16x16x32_bf16 v[172:175], a[92:95], a[36:39], v[172:175]
    ds_read_b128 a[108:111], v205 offset:22528
    v_cvt_pk_bf16_f32 v162, v164, v165
    v_mfma_f32_16x16x32_bf16 v[180:183], a[92:95], a[40:43], v[180:183]
    v_exp_f32 v166, v166
    v_mfma_f32_16x16x32_bf16 v[188:191], a[92:95], a[44:47], v[188:191]
    s_waitcnt lgkmcnt(3)
    buffer_load_dwordx4 v211, s[4:7], s24 offen offset:3072 lds
    v_mfma_f32_16x16x32_bf16 v[168:171], a[96:99], a[48:51], v[168:171]
    ds_read_b64_tr_b16 a[88:89], v214 offset:0
    ds_read_b64_tr_b16 a[90:91], v214 offset:2048
    v_mfma_f32_16x16x32_bf16 v[176:179], a[96:99], a[52:55], v[176:179]
    s_add_u32 m0, s15, 32768
    v_exp_f32 v167, v167
    v_mfma_f32_16x16x32_bf16 v[184:187], a[96:99], a[56:59], v[184:187]
    s_waitcnt lgkmcnt(4)
    buffer_load_dwordx4 v212, s[4:7], s24 offen offset:0 lds
    v_mfma_f32_16x16x32_bf16 v[172:175], a[100:103], a[48:51], v[172:175]
    ds_read_b64_tr_b16 a[92:93], v215 offset:0
    ds_read_b64_tr_b16 a[94:95], v215 offset:2048
    v_mfma_f32_16x16x32_bf16 v[180:183], a[100:103], a[52:55], v[180:183]
    buffer_load_dwordx4 v212, s[4:7], s24 offen offset:1024 lds
    v_mfma_f32_16x16x32_bf16 v[188:191], a[100:103], a[56:59], v[188:191]
    s_waitcnt lgkmcnt(5)
    s_add_u32 s40, s40, 30720
    v_cvt_pk_bf16_f32 v163, v166, v167
    s_nop 0
    v_mfma_f32_16x16x32_bf16 v[168:171], a[104:107], a[60:63], v[168:171]
    ds_read_b64_tr_b16 a[96:97], v216 offset:0
    ds_read_b64_tr_b16 a[98:99], v216 offset:2048
    v_mfma_f32_16x16x32_bf16 v[176:179], a[104:107], a[64:67], v[176:179]
    buffer_load_dwordx4 v212, s[4:7], s24 offen offset:2048 lds
    v_mfma_f32_16x16x32_bf16 v[184:187], a[104:107], a[68:71], v[184:187]
    s_waitcnt lgkmcnt(6)
    v_add_u32 v252, s40, v210
    v_mfma_f32_16x16x32_bf16 v[172:175], a[108:111], a[60:63], v[172:175]
    ds_read_b64_tr_b16 a[100:101], v217 offset:0
    ds_read_b64_tr_b16 a[102:103], v217 offset:2048
    v_mfma_f32_16x16x32_bf16 v[180:183], a[108:111], a[64:67], v[180:183]
    buffer_load_dwordx4 v212, s[4:7], s24 offen offset:3072 lds
    v_mfma_f32_16x16x32_bf16 v[188:191], a[108:111], a[68:71], v[188:191]
    s_waitcnt lgkmcnt(6)
    s_mul_i32 s40, s12, 3
    v_mfma_f32_16x16x32_bf16 a[72:75], a[84:87], v[144:147], a[72:75]
    v_exp_f32_e64 v168, v168
    v_mfma_f32_16x16x32_bf16 a[76:79], a[84:87], v[152:155], a[76:79]
    v_exp_f32 v169, v169
    v_mfma_f32_16x16x32_bf16 a[80:83], a[84:87], v[160:163], a[80:83]
    v_exp_f32 v170, v170
    v_mfma_f32_16x16x32_bf16 v[0:3], a[88:91], v[144:147], v[0:3]
    ds_read_b64_tr_b16 a[104:105], v218 offset:0
    ds_read_b64_tr_b16 a[106:107], v218 offset:2048
    v_mfma_f32_16x16x32_bf16 v[4:7], a[88:91], v[152:155], v[4:7]
    v_exp_f32_e64 v171, v171
    v_mfma_f32_16x16x32_bf16 v[8:11], a[88:91], v[160:163], v[8:11]
    s_waitcnt lgkmcnt(6)
    s_add_u32 s40, s40, 1
    v_mfma_f32_16x16x32_bf16 v[12:15], a[92:95], v[144:147], v[12:15]
    ds_read_b64_tr_b16 a[108:109], v219 offset:0
    ds_read_b64_tr_b16 a[110:111], v219 offset:2048
    v_mfma_f32_16x16x32_bf16 v[16:19], a[92:95], v[152:155], v[16:19]
    v_exp_f32 v172, v172
    v_mfma_f32_16x16x32_bf16 v[20:23], a[92:95], v[160:163], v[20:23]
    s_waitcnt lgkmcnt(6)
    buffer_load_dwordx2 v[238:239], v247, s[4:7], s31 offen
    v_mfma_f32_16x16x32_bf16 v[24:27], a[96:99], v[144:147], v[24:27]
    ds_read_b64_tr_b16 a[88:89], v220 offset:0
    ds_read_b64_tr_b16 a[90:91], v220 offset:2048
    v_mfma_f32_16x16x32_bf16 v[28:31], a[96:99], v[152:155], v[28:31]
    v_exp_f32_e64 v173, v173
    v_mfma_f32_16x16x32_bf16 v[32:35], a[96:99], v[160:163], v[32:35]
    s_waitcnt lgkmcnt(6)
    s_lshr_b32 s41, s40, 1
    v_mfma_f32_16x16x32_bf16 v[36:39], a[100:103], v[144:147], v[36:39]
    ds_read_b64_tr_b16 a[92:93], v221 offset:0
    ds_read_b64_tr_b16 a[94:95], v221 offset:2048
    v_mfma_f32_16x16x32_bf16 v[40:43], a[100:103], v[152:155], v[40:43]
    v_exp_f32 v174, v174
    v_mfma_f32_16x16x32_bf16 v[44:47], a[100:103], v[160:163], v[44:47]
    s_waitcnt lgkmcnt(6)
    buffer_load_dwordx2 v[240:241], v247, s[4:7], s32 offen
    v_mfma_f32_16x16x32_bf16 v[48:51], a[104:107], v[144:147], v[48:51]
    ds_read_b64_tr_b16 a[96:97], v222 offset:0
    ds_read_b64_tr_b16 a[98:99], v222 offset:2048
    v_mfma_f32_16x16x32_bf16 v[52:55], a[104:107], v[152:155], v[52:55]
    v_exp_f32 v175, v175
    v_mfma_f32_16x16x32_bf16 v[56:59], a[104:107], v[160:163], v[56:59]
    s_waitcnt lgkmcnt(6)
    s_mul_i32 s41, s41, 3072
    v_mfma_f32_16x16x32_bf16 v[60:63], a[108:111], v[144:147], v[60:63]
    ds_read_b64_tr_b16 a[100:101], v223 offset:0
    ds_read_b64_tr_b16 a[102:103], v223 offset:2048
    v_mfma_f32_16x16x32_bf16 v[64:67], a[108:111], v[152:155], v[64:67]
    v_exp_f32_e64 v176, v176
    v_mfma_f32_16x16x32_bf16 v[68:71], a[108:111], v[160:163], v[68:71]
    s_waitcnt lgkmcnt(6)
    s_and_b32 s40, s40, 1
    v_cvt_pk_bf16_f32 v168, v168, v169
    v_mfma_f32_16x16x32_bf16 v[72:75], a[88:91], v[144:147], v[72:75]
    ds_read_b64_tr_b16 a[104:105], v224 offset:0
    ds_read_b64_tr_b16 a[106:107], v224 offset:2048
    v_mfma_f32_16x16x32_bf16 v[76:79], a[88:91], v[152:155], v[76:79]
    v_exp_f32_e64 v177, v177
    v_mfma_f32_16x16x32_bf16 v[80:83], a[88:91], v[160:163], v[80:83]
    s_waitcnt lgkmcnt(6)
    s_lshl_b32 s40, s40, 3
    v_cvt_pk_bf16_f32 v169, v170, v171
    v_mfma_f32_16x16x32_bf16 v[84:87], a[92:95], v[144:147], v[84:87]
    ds_read_b64_tr_b16 a[108:109], v225 offset:0
    ds_read_b64_tr_b16 a[110:111], v225 offset:2048
    v_mfma_f32_16x16x32_bf16 v[88:91], a[92:95], v[152:155], v[88:91]
    v_exp_f32 v178, v178
    v_mfma_f32_16x16x32_bf16 v[92:95], a[92:95], v[160:163], v[92:95]
    s_waitcnt lgkmcnt(6)
    s_add_u32 s40, s40, s41
    v_cvt_pk_bf16_f32 v170, v172, v173
    v_mfma_f32_16x16x32_bf16 v[96:99], a[96:99], v[144:147], v[96:99]
    s_waitcnt vmcnt(10)
    ds_read_b128 a[88:91], v204 offset:24576
    v_mfma_f32_16x16x32_bf16 v[100:103], a[96:99], v[152:155], v[100:103]
    v_exp_f32 v179, v179
    v_mfma_f32_16x16x32_bf16 v[104:107], a[96:99], v[160:163], v[104:107]
    s_waitcnt lgkmcnt(5)
    s_add_u32 s40, s40, 30720
    v_cvt_pk_bf16_f32 v171, v174, v175
    v_mfma_f32_16x16x32_bf16 v[108:111], a[100:103], v[144:147], v[108:111]
    ds_read_b128 a[92:95], v204 offset:26624
    v_mfma_f32_16x16x32_bf16 v[112:115], a[100:103], v[152:155], v[112:115]
    v_exp_f32 v180, v180
    v_mfma_f32_16x16x32_bf16 v[116:119], a[100:103], v[160:163], v[116:119]
    s_waitcnt lgkmcnt(4)
    v_add_u32 v253, s40, v210
    v_mfma_f32_16x16x32_bf16 v[120:123], a[104:107], v[144:147], v[120:123]
    ds_read_b128 a[96:99], v205 offset:24576
    v_mfma_f32_16x16x32_bf16 v[124:127], a[104:107], v[152:155], v[124:127]
    v_exp_f32 v181, v181
    v_mfma_f32_16x16x32_bf16 v[128:131], a[104:107], v[160:163], v[128:131]
    s_waitcnt lgkmcnt(3)
    s_mul_i32 s40, s12, 3
    v_mfma_f32_16x16x32_bf16 v[132:135], a[108:111], v[144:147], v[132:135]
    ds_read_b128 a[100:103], v205 offset:26624
    v_mfma_f32_16x16x32_bf16 v[136:139], a[108:111], v[152:155], v[136:139]
    v_exp_f32 v182, v182
    v_mfma_f32_16x16x32_bf16 v[140:143], a[108:111], v[160:163], v[140:143]
    s_waitcnt lgkmcnt(3)
    s_add_u32 s40, s40, 2
    v_mfma_f32_16x16x32_bf16 v[144:147], a[88:91], a[0:3], v[192:195]
    s_waitcnt vmcnt(6)
    ds_read_b128 a[104:107], v204 offset:28672
    v_mfma_f32_16x16x32_bf16 v[152:155], a[88:91], a[4:7], v[196:199]
    s_add_u32 m0, s15, 0
    v_exp_f32_e64 v183, v183
    v_mfma_f32_16x16x32_bf16 v[160:163], a[88:91], a[8:11], v[200:203]
    s_waitcnt lgkmcnt(3)
    buffer_load_dwordx4 v210, s[4:7], s25 offen offset:0 lds
    v_mfma_f32_16x16x32_bf16 v[148:151], a[92:95], a[0:3], v[192:195]
    ds_read_b128 a[108:111], v204 offset:30720
    v_cvt_pk_bf16_f32 v176, v176, v177
    v_mfma_f32_16x16x32_bf16 v[156:159], a[92:95], a[4:7], v[196:199]
    v_exp_f32 v184, v184
    v_mfma_f32_16x16x32_bf16 v[164:167], a[92:95], a[8:11], v[200:203]
    s_waitcnt lgkmcnt(3)
    buffer_load_dwordx4 v210, s[4:7], s25 offen offset:1024 lds
    v_mfma_f32_16x16x32_bf16 v[144:147], a[96:99], a[12:15], v[144:147]
    ds_read_b128 a[88:91], v205 offset:28672
    v_cvt_pk_bf16_f32 v177, v178, v179
    v_mfma_f32_16x16x32_bf16 v[152:155], a[96:99], a[16:19], v[152:155]
    v_exp_f32 v185, v185
    v_mfma_f32_16x16x32_bf16 v[160:163], a[96:99], a[20:23], v[160:163]
    s_waitcnt lgkmcnt(3)
    buffer_load_dwordx4 v210, s[4:7], s25 offen offset:2048 lds
    v_mfma_f32_16x16x32_bf16 v[148:151], a[100:103], a[12:15], v[148:151]
    ds_read_b128 a[92:95], v205 offset:30720
    v_cvt_pk_bf16_f32 v178, v180, v181
    v_mfma_f32_16x16x32_bf16 v[156:159], a[100:103], a[16:19], v[156:159]
    v_exp_f32_e64 v186, v186
    v_mfma_f32_16x16x32_bf16 v[164:167], a[100:103], a[20:23], v[164:167]
    s_waitcnt lgkmcnt(3)
    buffer_load_dwordx4 v210, s[4:7], s25 offen offset:3072 lds
    v_mfma_f32_16x16x32_bf16 v[144:147], a[104:107], a[24:27], v[144:147]
    s_waitcnt vmcnt(6)
    ds_read_b128 a[96:99], v204 offset:32768
    v_cvt_pk_bf16_f32 v179, v182, v183
    v_mfma_f32_16x16x32_bf16 v[152:155], a[104:107], a[28:31], v[152:155]
    s_add_u32 m0, s15, 4096
    v_exp_f32 v187, v187
    v_mfma_f32_16x16x32_bf16 v[160:163], a[104:107], a[32:35], v[160:163]
    s_waitcnt lgkmcnt(3)
    buffer_load_dwordx4 v211, s[4:7], s25 offen offset:0 lds
    v_mfma_f32_16x16x32_bf16 v[148:151], a[108:111], a[24:27], v[148:151]
    ds_read_b128 a[100:103], v204 offset:34816
    v_cvt_pk_bf16_f32 v184, v184, v185
    v_mfma_f32_16x16x32_bf16 v[156:159], a[108:111], a[28:31], v[156:159]
    v_exp_f32_e64 v188, v188
    v_mfma_f32_16x16x32_bf16 v[164:167], a[108:111], a[32:35], v[164:167]
    s_waitcnt lgkmcnt(3)
    buffer_load_dwordx4 v211, s[4:7], s25 offen offset:1024 lds
    v_mfma_f32_16x16x32_bf16 v[144:147], a[88:91], a[36:39], v[144:147]
    ds_read_b128 a[104:107], v205 offset:32768
    v_cvt_pk_bf16_f32 v185, v186, v187
    v_mfma_f32_16x16x32_bf16 v[152:155], a[88:91], a[40:43], v[152:155]
    v_exp_f32 v189, v189
    v_mfma_f32_16x16x32_bf16 v[160:163], a[88:91], a[44:47], v[160:163]
    s_waitcnt lgkmcnt(3)
    buffer_load_dwordx4 v211, s[4:7], s25 offen offset:2048 lds
    v_mfma_f32_16x16x32_bf16 v[148:151], a[92:95], a[36:39], v[148:151]
    ds_read_b128 a[108:111], v205 offset:34816
    v_cvt_pk_bf16_f32 v186, v188, v189
    v_mfma_f32_16x16x32_bf16 v[156:159], a[92:95], a[40:43], v[156:159]
    v_exp_f32_e64 v190, v190
    v_mfma_f32_16x16x32_bf16 v[164:167], a[92:95], a[44:47], v[164:167]
    s_waitcnt lgkmcnt(3)
    buffer_load_dwordx4 v211, s[4:7], s25 offen offset:3072 lds
    v_mfma_f32_16x16x32_bf16 v[144:147], a[96:99], a[48:51], v[144:147]
    ds_read_b64_tr_b16 a[88:89], v214 offset:12288
    ds_read_b64_tr_b16 a[90:91], v214 offset:14336
    v_mfma_f32_16x16x32_bf16 v[152:155], a[96:99], a[52:55], v[152:155]
    s_add_u32 m0, s15, 8192
    v_exp_f32 v191, v191
    v_mfma_f32_16x16x32_bf16 v[160:163], a[96:99], a[56:59], v[160:163]
    s_waitcnt lgkmcnt(4)
    buffer_load_dwordx4 v212, s[4:7], s25 offen offset:0 lds
    v_mfma_f32_16x16x32_bf16 v[148:151], a[100:103], a[48:51], v[148:151]
    ds_read_b64_tr_b16 a[92:93], v215 offset:12288
    ds_read_b64_tr_b16 a[94:95], v215 offset:14336
    v_mfma_f32_16x16x32_bf16 v[156:159], a[100:103], a[52:55], v[156:159]
    buffer_load_dwordx4 v212, s[4:7], s25 offen offset:1024 lds
    v_mfma_f32_16x16x32_bf16 v[164:167], a[100:103], a[56:59], v[164:167]
    s_waitcnt lgkmcnt(5)
    s_lshr_b32 s41, s40, 1
    v_cvt_pk_bf16_f32 v187, v190, v191
    v_mfma_f32_16x16x32_bf16 v[144:147], a[104:107], a[60:63], v[144:147]
    ds_read_b64_tr_b16 a[96:97], v216 offset:12288
    ds_read_b64_tr_b16 a[98:99], v216 offset:14336
    v_mfma_f32_16x16x32_bf16 v[152:155], a[104:107], a[64:67], v[152:155]
    buffer_load_dwordx4 v212, s[4:7], s25 offen offset:2048 lds
    v_mfma_f32_16x16x32_bf16 v[160:163], a[104:107], a[68:71], v[160:163]
    s_waitcnt lgkmcnt(6)
    s_nop 0
    s_mul_i32 s41, s41, 3072
    v_mfma_f32_16x16x32_bf16 v[148:151], a[108:111], a[60:63], v[148:151]
    ds_read_b64_tr_b16 a[100:101], v217 offset:12288
    ds_read_b64_tr_b16 a[102:103], v217 offset:14336
    v_mfma_f32_16x16x32_bf16 v[156:159], a[108:111], a[64:67], v[156:159]
    buffer_load_dwordx4 v212, s[4:7], s25 offen offset:3072 lds
    v_mfma_f32_16x16x32_bf16 v[164:167], a[108:111], a[68:71], v[164:167]
    s_waitcnt lgkmcnt(6)
    s_and_b32 s40, s40, 1
    v_mfma_f32_16x16x32_bf16 a[72:75], a[84:87], v[168:171], a[72:75]
    v_exp_f32 v144, v144
    v_mfma_f32_16x16x32_bf16 a[76:79], a[84:87], v[176:179], a[76:79]
    v_exp_f32 v145, v145
    v_mfma_f32_16x16x32_bf16 a[80:83], a[84:87], v[184:187], a[80:83]
    v_exp_f32_e64 v146, v146
    v_mfma_f32_16x16x32_bf16 v[0:3], a[88:91], v[168:171], v[0:3]
    ds_read_b64_tr_b16 a[104:105], v218 offset:12288
    ds_read_b64_tr_b16 a[106:107], v218 offset:14336
    v_mfma_f32_16x16x32_bf16 v[4:7], a[88:91], v[176:179], v[4:7]
    v_exp_f32 v147, v147
    v_mfma_f32_16x16x32_bf16 v[8:11], a[88:91], v[184:187], v[8:11]
    s_waitcnt lgkmcnt(6)
    s_lshl_b32 s40, s40, 3
    v_mfma_f32_16x16x32_bf16 v[12:15], a[92:95], v[168:171], v[12:15]
    ds_read_b64_tr_b16 a[108:109], v219 offset:12288
    ds_read_b64_tr_b16 a[110:111], v219 offset:14336
    v_mfma_f32_16x16x32_bf16 v[16:19], a[92:95], v[176:179], v[16:19]
    v_exp_f32 v148, v148
    v_mfma_f32_16x16x32_bf16 v[20:23], a[92:95], v[184:187], v[20:23]
    s_waitcnt lgkmcnt(6)
    s_add_u32 s40, s40, s41
    v_mfma_f32_16x16x32_bf16 v[24:27], a[96:99], v[168:171], v[24:27]
    ds_read_b64_tr_b16 a[88:89], v220 offset:12288
    ds_read_b64_tr_b16 a[90:91], v220 offset:14336
    v_mfma_f32_16x16x32_bf16 v[28:31], a[96:99], v[176:179], v[28:31]
    v_exp_f32 v149, v149
    v_mfma_f32_16x16x32_bf16 v[32:35], a[96:99], v[184:187], v[32:35]
    s_waitcnt lgkmcnt(6)
    s_add_u32 s40, s40, 30720
    v_add_u32 v254, s40, v210
    v_add_u32 v255, 30720, v210
    v_mfma_f32_16x16x32_bf16 v[36:39], a[100:103], v[168:171], v[36:39]
    ds_read_b64_tr_b16 a[92:93], v221 offset:12288
    ds_read_b64_tr_b16 a[94:95], v221 offset:14336
    v_mfma_f32_16x16x32_bf16 v[40:43], a[100:103], v[176:179], v[40:43]
    v_exp_f32 v150, v150
    v_mfma_f32_16x16x32_bf16 v[44:47], a[100:103], v[184:187], v[44:47]
    s_waitcnt lgkmcnt(6)
    s_mov_b32 s35, 0xffff0000
    v_mfma_f32_16x16x32_bf16 v[48:51], a[104:107], v[168:171], v[48:51]
    ds_read_b64_tr_b16 a[96:97], v222 offset:12288
    ds_read_b64_tr_b16 a[98:99], v222 offset:14336
    v_mfma_f32_16x16x32_bf16 v[52:55], a[104:107], v[176:179], v[52:55]
    v_exp_f32_e64 v151, v151
    v_mfma_f32_16x16x32_bf16 v[56:59], a[104:107], v[184:187], v[56:59]
    s_waitcnt lgkmcnt(6)
    v_mfma_f32_16x16x32_bf16 v[60:63], a[108:111], v[168:171], v[60:63]
    ds_read_b64_tr_b16 a[100:101], v223 offset:12288
    ds_read_b64_tr_b16 a[102:103], v223 offset:14336
    v_mfma_f32_16x16x32_bf16 v[64:67], a[108:111], v[176:179], v[64:67]
    v_exp_f32 v152, v152
    v_mfma_f32_16x16x32_bf16 v[68:71], a[108:111], v[184:187], v[68:71]
    s_waitcnt lgkmcnt(6)
    v_cvt_pk_bf16_f32 v144, v144, v145
    v_mfma_f32_16x16x32_bf16 v[72:75], a[88:91], v[168:171], v[72:75]
    ds_read_b64_tr_b16 a[104:105], v224 offset:12288
    ds_read_b64_tr_b16 a[106:107], v224 offset:14336
    v_mfma_f32_16x16x32_bf16 v[76:79], a[88:91], v[176:179], v[76:79]
    v_exp_f32 v153, v153
    v_mfma_f32_16x16x32_bf16 v[80:83], a[88:91], v[184:187], v[80:83]
    s_waitcnt lgkmcnt(6)
    v_cvt_pk_bf16_f32 v145, v146, v147
    v_mfma_f32_16x16x32_bf16 v[84:87], a[92:95], v[168:171], v[84:87]
    ds_read_b64_tr_b16 a[108:109], v225 offset:12288
    ds_read_b64_tr_b16 a[110:111], v225 offset:14336
    v_mfma_f32_16x16x32_bf16 v[88:91], a[92:95], v[176:179], v[88:91]
    v_exp_f32_e64 v154, v154
    v_mfma_f32_16x16x32_bf16 v[92:95], a[92:95], v[184:187], v[92:95]
    s_waitcnt lgkmcnt(6)
    v_cvt_pk_bf16_f32 v146, v148, v149
    v_mfma_f32_16x16x32_bf16 v[96:99], a[96:99], v[168:171], v[96:99]
    s_waitcnt vmcnt(8)
    ds_read_b128 a[88:91], v204 offset:0
    v_mfma_f32_16x16x32_bf16 v[100:103], a[96:99], v[176:179], v[100:103]
    v_exp_f32 v155, v155
    v_mfma_f32_16x16x32_bf16 v[104:107], a[96:99], v[184:187], v[104:107]
    s_waitcnt lgkmcnt(5)
    v_cvt_pk_bf16_f32 v147, v150, v151
    v_mfma_f32_16x16x32_bf16 v[108:111], a[100:103], v[168:171], v[108:111]
    ds_read_b128 a[92:95], v204 offset:2048
    v_mfma_f32_16x16x32_bf16 v[112:115], a[100:103], v[176:179], v[112:115]
    v_exp_f32_e64 v156, v156
    v_mfma_f32_16x16x32_bf16 v[116:119], a[100:103], v[184:187], v[116:119]
    s_waitcnt lgkmcnt(4)
    v_mfma_f32_16x16x32_bf16 v[120:123], a[104:107], v[168:171], v[120:123]
    ds_read_b128 a[96:99], v205 offset:0
    v_mfma_f32_16x16x32_bf16 v[124:127], a[104:107], v[176:179], v[124:127]
    v_exp_f32_e64 v157, v157
    v_mfma_f32_16x16x32_bf16 v[128:131], a[104:107], v[184:187], v[128:131]
    s_waitcnt lgkmcnt(3)
    v_mfma_f32_16x16x32_bf16 v[132:135], a[108:111], v[168:171], v[132:135]
    ds_read_b128 a[100:103], v205 offset:2048
    v_mfma_f32_16x16x32_bf16 v[136:139], a[108:111], v[176:179], v[136:139]
    v_exp_f32 v158, v158
    v_mfma_f32_16x16x32_bf16 v[140:143], a[108:111], v[184:187], v[140:143]
    s_waitcnt lgkmcnt(3)
    v_mfma_f32_16x16x32_bf16 v[168:171], a[88:91], a[0:3], v[192:195]
    s_waitcnt vmcnt(4)
    ds_read_b128 a[104:107], v204 offset:4096
    v_mfma_f32_16x16x32_bf16 v[176:179], a[88:91], a[4:7], v[196:199]
    v_exp_f32 v159, v159
    v_mfma_f32_16x16x32_bf16 v[184:187], a[88:91], a[8:11], v[200:203]
    s_waitcnt lgkmcnt(3)
    v_mfma_f32_16x16x32_bf16 v[172:175], a[92:95], a[0:3], v[192:195]
    ds_read_b128 a[108:111], v204 offset:6144
    v_cvt_pk_bf16_f32 v152, v152, v153
    v_mfma_f32_16x16x32_bf16 v[180:183], a[92:95], a[4:7], v[196:199]
    v_exp_f32_e64 v160, v160
    v_mfma_f32_16x16x32_bf16 v[188:191], a[92:95], a[8:11], v[200:203]
    s_waitcnt lgkmcnt(3)
    v_mfma_f32_16x16x32_bf16 v[168:171], a[96:99], a[12:15], v[168:171]
    ds_read_b128 a[88:91], v205 offset:4096
    v_cvt_pk_bf16_f32 v153, v154, v155
    v_mfma_f32_16x16x32_bf16 v[176:179], a[96:99], a[16:19], v[176:179]
    v_exp_f32 v161, v161
    v_mfma_f32_16x16x32_bf16 v[184:187], a[96:99], a[20:23], v[184:187]
    s_waitcnt lgkmcnt(3)
    v_mfma_f32_16x16x32_bf16 v[172:175], a[100:103], a[12:15], v[172:175]
    ds_read_b128 a[92:95], v205 offset:6144
    v_cvt_pk_bf16_f32 v154, v156, v157
    v_mfma_f32_16x16x32_bf16 v[180:183], a[100:103], a[16:19], v[180:183]
    v_exp_f32_e64 v162, v162
    v_mfma_f32_16x16x32_bf16 v[188:191], a[100:103], a[20:23], v[188:191]
    s_waitcnt lgkmcnt(3)
    v_mfma_f32_16x16x32_bf16 v[168:171], a[104:107], a[24:27], v[168:171]
    s_waitcnt vmcnt(0)
    ds_read_b128 a[96:99], v204 offset:8192
    v_cvt_pk_bf16_f32 v155, v158, v159
    v_mfma_f32_16x16x32_bf16 v[176:179], a[104:107], a[28:31], v[176:179]
    v_exp_f32 v163, v163
    v_mfma_f32_16x16x32_bf16 v[184:187], a[104:107], a[32:35], v[184:187]
    s_waitcnt lgkmcnt(3)
    v_mfma_f32_16x16x32_bf16 v[172:175], a[108:111], a[24:27], v[172:175]
    ds_read_b128 a[100:103], v204 offset:10240
    v_cvt_pk_bf16_f32 v160, v160, v161
    v_mfma_f32_16x16x32_bf16 v[180:183], a[108:111], a[28:31], v[180:183]
    v_exp_f32_e64 v164, v164
    v_mfma_f32_16x16x32_bf16 v[188:191], a[108:111], a[32:35], v[188:191]
    s_waitcnt lgkmcnt(3)
    v_mfma_f32_16x16x32_bf16 v[168:171], a[88:91], a[36:39], v[168:171]
    ds_read_b128 a[104:107], v205 offset:8192
    v_cvt_pk_bf16_f32 v161, v162, v163
    v_mfma_f32_16x16x32_bf16 v[176:179], a[88:91], a[40:43], v[176:179]
    v_exp_f32_e64 v165, v165
    v_mfma_f32_16x16x32_bf16 v[184:187], a[88:91], a[44:47], v[184:187]
    s_waitcnt lgkmcnt(3)
    v_mfma_f32_16x16x32_bf16 v[172:175], a[92:95], a[36:39], v[172:175]
    ds_read_b128 a[108:111], v205 offset:10240
    v_cvt_pk_bf16_f32 v162, v164, v165
    v_mfma_f32_16x16x32_bf16 v[180:183], a[92:95], a[40:43], v[180:183]
    v_exp_f32 v166, v166
    v_mfma_f32_16x16x32_bf16 v[188:191], a[92:95], a[44:47], v[188:191]
    s_waitcnt lgkmcnt(3)
    v_mfma_f32_16x16x32_bf16 v[168:171], a[96:99], a[48:51], v[168:171]
    ds_read_b64_tr_b16 a[88:89], v214 offset:24576
    ds_read_b64_tr_b16 a[90:91], v214 offset:26624
    v_mfma_f32_16x16x32_bf16 v[176:179], a[96:99], a[52:55], v[176:179]
    v_exp_f32 v167, v167
    v_mfma_f32_16x16x32_bf16 v[184:187], a[96:99], a[56:59], v[184:187]
    s_waitcnt lgkmcnt(4)
    v_mfma_f32_16x16x32_bf16 v[172:175], a[100:103], a[48:51], v[172:175]
    ds_read_b64_tr_b16 a[92:93], v215 offset:24576
    ds_read_b64_tr_b16 a[94:95], v215 offset:26624
    v_mfma_f32_16x16x32_bf16 v[180:183], a[100:103], a[52:55], v[180:183]
    v_mfma_f32_16x16x32_bf16 v[188:191], a[100:103], a[56:59], v[188:191]
    s_waitcnt lgkmcnt(5)
    v_cvt_pk_bf16_f32 v163, v166, v167
    v_mfma_f32_16x16x32_bf16 v[168:171], a[104:107], a[60:63], v[168:171]
    ds_read_b64_tr_b16 a[96:97], v216 offset:24576
    ds_read_b64_tr_b16 a[98:99], v216 offset:26624
    v_mfma_f32_16x16x32_bf16 v[176:179], a[104:107], a[64:67], v[176:179]
    v_mfma_f32_16x16x32_bf16 v[184:187], a[104:107], a[68:71], v[184:187]
    s_waitcnt lgkmcnt(6)
    v_mfma_f32_16x16x32_bf16 v[172:175], a[108:111], a[60:63], v[172:175]
    ds_read_b64_tr_b16 a[100:101], v217 offset:24576
    ds_read_b64_tr_b16 a[102:103], v217 offset:26624
    v_mfma_f32_16x16x32_bf16 v[180:183], a[108:111], a[64:67], v[180:183]
    v_mfma_f32_16x16x32_bf16 v[188:191], a[108:111], a[68:71], v[188:191]
    s_waitcnt lgkmcnt(6)
    v_mfma_f32_16x16x32_bf16 a[72:75], a[84:87], v[144:147], a[72:75]
    v_exp_f32 v168, v168
    v_mfma_f32_16x16x32_bf16 a[76:79], a[84:87], v[152:155], a[76:79]
    v_exp_f32 v169, v169
    v_mfma_f32_16x16x32_bf16 a[80:83], a[84:87], v[160:163], a[80:83]
    v_exp_f32 v170, v170
    v_mfma_f32_16x16x32_bf16 v[0:3], a[88:91], v[144:147], v[0:3]
    ds_read_b64_tr_b16 a[104:105], v218 offset:24576
    ds_read_b64_tr_b16 a[106:107], v218 offset:26624
    v_cvt_pk_bf16_f32 v168, v168, v169
    v_mfma_f32_16x16x32_bf16 v[4:7], a[88:91], v[152:155], v[4:7]
    v_exp_f32_e64 v171, v171
    v_mfma_f32_16x16x32_bf16 v[8:11], a[88:91], v[160:163], v[8:11]
    s_waitcnt lgkmcnt(6)
    v_exp_f32 v172, v172
    v_mfma_f32_16x16x32_bf16 v[12:15], a[92:95], v[144:147], v[12:15]
    ds_read_b64_tr_b16 a[108:109], v219 offset:24576
    ds_read_b64_tr_b16 a[110:111], v219 offset:26624
    v_cvt_pk_bf16_f32 v169, v170, v171
    v_mfma_f32_16x16x32_bf16 v[16:19], a[92:95], v[152:155], v[16:19]
    v_exp_f32_e64 v173, v173
    v_mfma_f32_16x16x32_bf16 v[20:23], a[92:95], v[160:163], v[20:23]
    s_waitcnt lgkmcnt(6)
    v_exp_f32 v174, v174
    v_mfma_f32_16x16x32_bf16 v[24:27], a[96:99], v[144:147], v[24:27]
    ds_read_b64_tr_b16 a[88:89], v220 offset:24576
    ds_read_b64_tr_b16 a[90:91], v220 offset:26624
    v_cvt_pk_bf16_f32 v170, v172, v173
    v_mfma_f32_16x16x32_bf16 v[28:31], a[96:99], v[152:155], v[28:31]
    v_exp_f32_e64 v175, v175
    v_mfma_f32_16x16x32_bf16 v[32:35], a[96:99], v[160:163], v[32:35]
    s_waitcnt lgkmcnt(6)
    v_exp_f32 v176, v176
    v_mfma_f32_16x16x32_bf16 v[36:39], a[100:103], v[144:147], v[36:39]
    ds_read_b64_tr_b16 a[92:93], v221 offset:24576
    ds_read_b64_tr_b16 a[94:95], v221 offset:26624
    v_cvt_pk_bf16_f32 v171, v174, v175
    v_mfma_f32_16x16x32_bf16 v[40:43], a[100:103], v[152:155], v[40:43]
    v_exp_f32_e64 v177, v177
    v_mfma_f32_16x16x32_bf16 v[44:47], a[100:103], v[160:163], v[44:47]
    s_waitcnt lgkmcnt(6)
    v_exp_f32 v178, v178
    v_mfma_f32_16x16x32_bf16 v[48:51], a[104:107], v[144:147], v[48:51]
    ds_read_b64_tr_b16 a[96:97], v222 offset:24576
    ds_read_b64_tr_b16 a[98:99], v222 offset:26624
    v_cvt_pk_bf16_f32 v176, v176, v177
    v_mfma_f32_16x16x32_bf16 v[52:55], a[104:107], v[152:155], v[52:55]
    v_exp_f32_e64 v179, v179
    v_mfma_f32_16x16x32_bf16 v[56:59], a[104:107], v[160:163], v[56:59]
    s_waitcnt lgkmcnt(6)
    v_exp_f32 v180, v180
    v_mfma_f32_16x16x32_bf16 v[60:63], a[108:111], v[144:147], v[60:63]
    ds_read_b64_tr_b16 a[100:101], v223 offset:24576
    ds_read_b64_tr_b16 a[102:103], v223 offset:26624
    v_cvt_pk_bf16_f32 v177, v178, v179
    v_mfma_f32_16x16x32_bf16 v[64:67], a[108:111], v[152:155], v[64:67]
    v_exp_f32_e64 v181, v181
    v_mfma_f32_16x16x32_bf16 v[68:71], a[108:111], v[160:163], v[68:71]
    s_waitcnt lgkmcnt(6)
    v_exp_f32 v182, v182
    v_mfma_f32_16x16x32_bf16 v[72:75], a[88:91], v[144:147], v[72:75]
    ds_read_b64_tr_b16 a[104:105], v224 offset:24576
    ds_read_b64_tr_b16 a[106:107], v224 offset:26624
    v_cvt_pk_bf16_f32 v178, v180, v181
    v_mfma_f32_16x16x32_bf16 v[76:79], a[88:91], v[152:155], v[76:79]
    v_exp_f32_e64 v183, v183
    v_mfma_f32_16x16x32_bf16 v[80:83], a[88:91], v[160:163], v[80:83]
    s_waitcnt lgkmcnt(6)
    v_exp_f32 v184, v184
    v_mfma_f32_16x16x32_bf16 v[84:87], a[92:95], v[144:147], v[84:87]
    ds_read_b64_tr_b16 a[108:109], v225 offset:24576
    ds_read_b64_tr_b16 a[110:111], v225 offset:26624
    v_cvt_pk_bf16_f32 v179, v182, v183
    v_mfma_f32_16x16x32_bf16 v[88:91], a[92:95], v[152:155], v[88:91]
    v_exp_f32_e64 v185, v185
    v_mfma_f32_16x16x32_bf16 v[92:95], a[92:95], v[160:163], v[92:95]
    s_waitcnt lgkmcnt(6)
    v_exp_f32 v186, v186
    v_mfma_f32_16x16x32_bf16 v[96:99], a[96:99], v[144:147], v[96:99]
    ds_read_b64_tr_b16 a[88:89], v214 offset:0
    ds_read_b64_tr_b16 a[90:91], v214 offset:2048
    v_cvt_pk_bf16_f32 v184, v184, v185
    v_mfma_f32_16x16x32_bf16 v[100:103], a[96:99], v[152:155], v[100:103]
    v_exp_f32_e64 v187, v187
    v_mfma_f32_16x16x32_bf16 v[104:107], a[96:99], v[160:163], v[104:107]
    s_waitcnt lgkmcnt(6)
    v_exp_f32 v188, v188
    v_mfma_f32_16x16x32_bf16 v[108:111], a[100:103], v[144:147], v[108:111]
    ds_read_b64_tr_b16 a[92:93], v215 offset:0
    ds_read_b64_tr_b16 a[94:95], v215 offset:2048
    v_cvt_pk_bf16_f32 v185, v186, v187
    v_mfma_f32_16x16x32_bf16 v[112:115], a[100:103], v[152:155], v[112:115]
    v_exp_f32_e64 v189, v189
    v_mfma_f32_16x16x32_bf16 v[116:119], a[100:103], v[160:163], v[116:119]
    s_waitcnt lgkmcnt(6)
    v_exp_f32 v190, v190
    v_mfma_f32_16x16x32_bf16 v[120:123], a[104:107], v[144:147], v[120:123]
    ds_read_b64_tr_b16 a[96:97], v216 offset:0
    ds_read_b64_tr_b16 a[98:99], v216 offset:2048
    v_cvt_pk_bf16_f32 v186, v188, v189
    v_mfma_f32_16x16x32_bf16 v[124:127], a[104:107], v[152:155], v[124:127]
    v_exp_f32_e64 v191, v191
    v_mfma_f32_16x16x32_bf16 v[128:131], a[104:107], v[160:163], v[128:131]
    s_waitcnt lgkmcnt(6)
    buffer_load_dwordx4 v[192:195], v245, s[4:7], s27 offen
    v_mfma_f32_16x16x32_bf16 v[132:135], a[108:111], v[144:147], v[132:135]
    ds_read_b64_tr_b16 a[100:101], v217 offset:0
    ds_read_b64_tr_b16 a[102:103], v217 offset:2048
    v_cvt_pk_bf16_f32 v187, v190, v191
    v_mfma_f32_16x16x32_bf16 v[136:139], a[108:111], v[152:155], v[136:139]
    s_nop 0
    buffer_load_dwordx2 v[196:197], v246, s[4:7], s27 offen
    v_mfma_f32_16x16x32_bf16 v[140:143], a[108:111], v[160:163], v[140:143]
    s_waitcnt lgkmcnt(6)
    buffer_load_dwordx4 v[198:201], v245, s[4:7], s28 offen
    v_mfma_f32_16x16x32_bf16 a[72:75], a[84:87], v[168:171], a[72:75]
    buffer_load_dwordx2 v[202:203], v246, s[4:7], s28 offen
    v_mfma_f32_16x16x32_bf16 a[76:79], a[84:87], v[176:179], a[76:79]
    v_mfma_f32_16x16x32_bf16 a[80:83], a[84:87], v[184:187], a[80:83]
    s_nop 0
    v_mfma_f32_16x16x32_bf16 v[0:3], a[88:91], v[168:171], v[0:3]
    ds_read_b64_tr_b16 a[104:105], v218 offset:0
    ds_read_b64_tr_b16 a[106:107], v218 offset:2048
    v_mfma_f32_16x16x32_bf16 v[4:7], a[88:91], v[176:179], v[4:7]
    v_mfma_f32_16x16x32_bf16 v[8:11], a[88:91], v[184:187], v[8:11]
    s_waitcnt lgkmcnt(6)
    v_mfma_f32_16x16x32_bf16 v[12:15], a[92:95], v[168:171], v[12:15]
    ds_read_b64_tr_b16 a[108:109], v219 offset:0
    s_nop 0
    ds_read_b64_tr_b16 a[110:111], v219 offset:2048
    v_mfma_f32_16x16x32_bf16 v[16:19], a[92:95], v[176:179], v[16:19]
    v_mfma_f32_16x16x32_bf16 v[20:23], a[92:95], v[184:187], v[20:23]
    s_waitcnt lgkmcnt(6)
    v_mfma_f32_16x16x32_bf16 v[24:27], a[96:99], v[168:171], v[24:27]
    ds_read_b64_tr_b16 a[88:89], v220 offset:0
    ds_read_b64_tr_b16 a[90:91], v220 offset:2048
    v_mfma_f32_16x16x32_bf16 v[28:31], a[96:99], v[176:179], v[28:31]
    s_nop 0
    v_cvt_pk_bf16_f32 v0, v0, v1
    v_cvt_pk_bf16_f32 v1, v2, v3
    v_mfma_f32_16x16x32_bf16 v[32:35], a[96:99], v[184:187], v[32:35]
    s_waitcnt lgkmcnt(6)
    ds_write_b64 v213, v[0:1] offset:0
    v_cvt_pk_bf16_f32 v4, v4, v5
    v_mfma_f32_16x16x32_bf16 v[36:39], a[100:103], v[168:171], v[36:39]
    ds_read_b64_tr_b16 a[92:93], v221 offset:0
    s_nop 0
    ds_read_b64_tr_b16 a[94:95], v221 offset:2048
    v_mfma_f32_16x16x32_bf16 v[40:43], a[100:103], v[176:179], v[40:43]
    v_cvt_pk_bf16_f32 v5, v6, v7
    v_cvt_pk_bf16_f32 v8, v8, v9
    v_mfma_f32_16x16x32_bf16 v[44:47], a[100:103], v[184:187], v[44:47]
    s_waitcnt lgkmcnt(7)
    ds_write_b64 v213, v[4:5] offset:512
    v_cvt_pk_bf16_f32 v9, v10, v11
    s_nop 0
    v_mfma_f32_16x16x32_bf16 v[48:51], a[104:107], v[168:171], v[48:51]
    ds_read_b64_tr_b16 a[96:97], v222 offset:0
    ds_read_b64_tr_b16 a[98:99], v222 offset:2048
    v_mfma_f32_16x16x32_bf16 v[52:55], a[104:107], v[176:179], v[52:55]
    ds_write_b64 v213, v[8:9] offset:1024
    v_cvt_pk_bf16_f32 v12, v12, v13
    v_mfma_f32_16x16x32_bf16 v[56:59], a[104:107], v[184:187], v[56:59]
    s_waitcnt lgkmcnt(9)
    s_nop 0
    v_cvt_pk_bf16_f32 v13, v14, v15
    v_cvt_pk_bf16_f32 v16, v16, v17
    v_mfma_f32_16x16x32_bf16 v[60:63], a[108:111], v[168:171], v[60:63]
    ds_read_b64_tr_b16 a[100:101], v223 offset:0
    ds_read_b64_tr_b16 a[102:103], v223 offset:2048
    v_mfma_f32_16x16x32_bf16 v[64:67], a[108:111], v[176:179], v[64:67]
    ds_write_b64 v213, v[12:13] offset:1536
    v_cvt_pk_bf16_f32 v17, v18, v19
    v_mfma_f32_16x16x32_bf16 v[68:71], a[108:111], v[184:187], v[68:71]
    s_waitcnt lgkmcnt(10)
    ds_write_b64 v213, v[16:17] offset:2048
    v_cvt_pk_bf16_f32 v20, v20, v21
    v_mfma_f32_16x16x32_bf16 v[72:75], a[88:91], v[168:171], v[72:75]
    ds_read_b64_tr_b16 a[104:105], v224 offset:0
    ds_read_b64_tr_b16 a[106:107], v224 offset:2048
    v_mfma_f32_16x16x32_bf16 v[76:79], a[88:91], v[176:179], v[76:79]
    s_nop 0
    v_cvt_pk_bf16_f32 v21, v22, v23
    v_cvt_pk_bf16_f32 v24, v24, v25
    v_mfma_f32_16x16x32_bf16 v[80:83], a[88:91], v[184:187], v[80:83]
    s_waitcnt lgkmcnt(10)
    ds_write_b64 v213, v[20:21] offset:2560
    v_cvt_pk_bf16_f32 v25, v26, v27
    v_mfma_f32_16x16x32_bf16 v[84:87], a[92:95], v[168:171], v[84:87]
    ds_read_b64_tr_b16 a[108:109], v225 offset:0
    s_nop 0
    ds_read_b64_tr_b16 a[110:111], v225 offset:2048
    v_mfma_f32_16x16x32_bf16 v[88:91], a[92:95], v[176:179], v[88:91]
    ds_write_b64 v213, v[24:25] offset:3072
    v_cvt_pk_bf16_f32 v28, v28, v29
    v_mfma_f32_16x16x32_bf16 v[92:95], a[92:95], v[184:187], v[92:95]
    s_waitcnt lgkmcnt(11)
    v_cvt_pk_bf16_f32 v29, v30, v31
    v_cvt_pk_bf16_f32 v32, v32, v33
    s_nop 0
    v_mfma_f32_16x16x32_bf16 v[96:99], a[96:99], v[168:171], v[96:99]
    ds_write_b64 v213, v[28:29] offset:3584
    v_cvt_pk_bf16_f32 v33, v34, v35
    v_mfma_f32_16x16x32_bf16 v[100:103], a[96:99], v[176:179], v[100:103]
    ds_write_b64 v213, v[32:33] offset:4096
    v_cvt_pk_bf16_f32 v36, v36, v37
    v_mfma_f32_16x16x32_bf16 v[104:107], a[96:99], v[184:187], v[104:107]
    s_waitcnt lgkmcnt(10)
    s_nop 0
    v_cvt_pk_bf16_f32 v37, v38, v39
    v_cvt_pk_bf16_f32 v40, v40, v41
    v_mfma_f32_16x16x32_bf16 v[108:111], a[100:103], v[168:171], v[108:111]
    ds_write_b64 v213, v[36:37] offset:4608
    v_cvt_pk_bf16_f32 v41, v42, v43
    v_mfma_f32_16x16x32_bf16 v[112:115], a[100:103], v[176:179], v[112:115]
    ds_write_b64 v213, v[40:41] offset:5120
    v_cvt_pk_bf16_f32 v44, v44, v45
    v_mfma_f32_16x16x32_bf16 v[116:119], a[100:103], v[184:187], v[116:119]
    s_waitcnt lgkmcnt(8)
    v_cvt_pk_bf16_f32 v45, v46, v47
    v_cvt_pk_bf16_f32 v48, v48, v49
    v_mfma_f32_16x16x32_bf16 v[120:123], a[104:107], v[168:171], v[120:123]
    ds_write_b64 v213, v[44:45] offset:5632
    v_cvt_pk_bf16_f32 v49, v50, v51
    v_mfma_f32_16x16x32_bf16 v[124:127], a[104:107], v[176:179], v[124:127]
    s_nop 0
    ds_write_b64 v213, v[48:49] offset:6144
    v_cvt_pk_bf16_f32 v52, v52, v53
    v_mfma_f32_16x16x32_bf16 v[128:131], a[104:107], v[184:187], v[128:131]
    s_waitcnt lgkmcnt(7)
    v_cvt_pk_bf16_f32 v53, v54, v55
    v_cvt_pk_bf16_f32 v56, v56, v57
    v_mfma_f32_16x16x32_bf16 v[132:135], a[108:111], v[168:171], v[132:135]
    ds_write_b64 v213, v[52:53] offset:6656
    s_nop 0
    v_cvt_pk_bf16_f32 v57, v58, v59
    v_mfma_f32_16x16x32_bf16 v[136:139], a[108:111], v[176:179], v[136:139]
    ds_write_b64 v213, v[56:57] offset:7168
    v_cvt_pk_bf16_f32 v60, v60, v61
    v_mfma_f32_16x16x32_bf16 v[140:143], a[108:111], v[184:187], v[140:143]
    v_cvt_pk_bf16_f32 v61, v62, v63
    v_cvt_pk_bf16_f32 v64, v64, v65
    ds_write_b64 v213, v[60:61] offset:7680
    v_cvt_pk_bf16_f32 v65, v66, v67
    ds_write_b64 v213, v[64:65] offset:8192
    v_cvt_pk_bf16_f32 v68, v68, v69
    v_cvt_pk_bf16_f32 v69, v70, v71
    ds_write_b64 v213, v[68:69] offset:8704
    v_cvt_pk_bf16_f32 v72, v72, v73
    v_cvt_pk_bf16_f32 v73, v74, v75
    ds_write_b64 v213, v[72:73] offset:9216
    v_cvt_pk_bf16_f32 v76, v76, v77
    v_cvt_pk_bf16_f32 v77, v78, v79
    ds_write_b64 v213, v[76:77] offset:9728
    v_cvt_pk_bf16_f32 v80, v80, v81
    v_cvt_pk_bf16_f32 v81, v82, v83
    ds_write_b64 v213, v[80:81] offset:10240
    v_cvt_pk_bf16_f32 v84, v84, v85
    v_cvt_pk_bf16_f32 v85, v86, v87
    ds_write_b64 v213, v[84:85] offset:10752
    v_cvt_pk_bf16_f32 v88, v88, v89
    v_cvt_pk_bf16_f32 v89, v90, v91
    ds_write_b64 v213, v[88:89] offset:11264
    v_cvt_pk_bf16_f32 v92, v92, v93
    v_cvt_pk_bf16_f32 v93, v94, v95
    ds_write_b64 v213, v[92:93] offset:11776
    v_cvt_pk_bf16_f32 v96, v96, v97
    v_cvt_pk_bf16_f32 v97, v98, v99
    ds_write_b64 v213, v[96:97] offset:12288
    v_cvt_pk_bf16_f32 v100, v100, v101
    v_cvt_pk_bf16_f32 v101, v102, v103
    ds_write_b64 v213, v[100:101] offset:12800
    v_cvt_pk_bf16_f32 v104, v104, v105
    v_cvt_pk_bf16_f32 v105, v106, v107
    ds_write_b64 v213, v[104:105] offset:13312
    ds_write_b32 v249, a72 offset:0
    ds_write_b32 v249, a76 offset:256
    ds_write_b32 v249, a80 offset:512
    s_waitcnt vmcnt(3)
    v_lshlrev_b32 v0, 16, v192
    v_and_b32 v1, s35, v192
    v_lshlrev_b32 v2, 16, v193
    v_and_b32 v3, s35, v193
    v_lshlrev_b32 v4, 16, v194
    v_and_b32 v5, s35, v194
    v_lshlrev_b32 v6, 16, v195
    v_and_b32 v7, s35, v195
    s_waitcnt vmcnt(2)
    v_lshlrev_b32 v8, 16, v196
    v_and_b32 v9, s35, v196
    v_lshlrev_b32 v10, 16, v197
    v_and_b32 v11, s35, v197
    s_waitcnt vmcnt(1)
    v_lshlrev_b32 v12, 16, v198
    v_and_b32 v13, s35, v198
    v_lshlrev_b32 v14, 16, v199
    v_and_b32 v15, s35, v199
    v_lshlrev_b32 v16, 16, v200
    v_and_b32 v17, s35, v200
    v_lshlrev_b32 v18, 16, v201
    v_and_b32 v19, s35, v201
    s_waitcnt vmcnt(0)
    v_lshlrev_b32 v20, 16, v202
    v_and_b32 v21, s35, v202
    v_lshlrev_b32 v22, 16, v203
    v_and_b32 v23, s35, v203
    v_lshlrev_b32 v24, 16, v230
    v_and_b32 v25, s35, v230
    v_lshlrev_b32 v26, 16, v231
    v_and_b32 v27, s35, v231
    v_lshlrev_b32 v28, 16, v232
    v_and_b32 v29, s35, v232
    v_lshlrev_b32 v30, 16, v233
    v_and_b32 v31, s35, v233
    v_lshlrev_b32 v32, 16, v234
    v_and_b32 v33, s35, v234
    v_lshlrev_b32 v34, 16, v235
    v_and_b32 v35, s35, v235
    v_pk_fma_f32 v[0:1], v[0:1], v[236:237], v[236:237] op_sel:[0,1,0] op_sel_hi:[1,1,0]
    v_pk_fma_f32 v[2:3], v[2:3], v[236:237], v[236:237] op_sel:[0,1,0] op_sel_hi:[1,1,0]
    v_pk_fma_f32 v[4:5], v[4:5], v[236:237], v[236:237] op_sel:[0,1,0] op_sel_hi:[1,1,0]
    v_pk_fma_f32 v[6:7], v[6:7], v[236:237], v[236:237] op_sel:[0,1,0] op_sel_hi:[1,1,0]
    v_pk_fma_f32 v[8:9], v[8:9], v[236:237], v[236:237] op_sel:[0,1,0] op_sel_hi:[1,1,0]
    v_pk_fma_f32 v[10:11], v[10:11], v[236:237], v[236:237] op_sel:[0,1,0] op_sel_hi:[1,1,0]
    v_pk_fma_f32 v[12:13], v[12:13], v[238:239], v[238:239] op_sel:[0,1,0] op_sel_hi:[1,1,0]
    v_pk_fma_f32 v[14:15], v[14:15], v[238:239], v[238:239] op_sel:[0,1,0] op_sel_hi:[1,1,0]
    v_pk_fma_f32 v[16:17], v[16:17], v[238:239], v[238:239] op_sel:[0,1,0] op_sel_hi:[1,1,0]
    v_pk_fma_f32 v[18:19], v[18:19], v[238:239], v[238:239] op_sel:[0,1,0] op_sel_hi:[1,1,0]
    v_pk_fma_f32 v[20:21], v[20:21], v[238:239], v[238:239] op_sel:[0,1,0] op_sel_hi:[1,1,0]
    v_pk_fma_f32 v[22:23], v[22:23], v[238:239], v[238:239] op_sel:[0,1,0] op_sel_hi:[1,1,0]
    v_pk_fma_f32 v[24:25], v[24:25], v[240:241], v[240:241] op_sel:[0,1,0] op_sel_hi:[1,1,0]
    v_pk_fma_f32 v[26:27], v[26:27], v[240:241], v[240:241] op_sel:[0,1,0] op_sel_hi:[1,1,0]
    v_pk_fma_f32 v[28:29], v[28:29], v[240:241], v[240:241] op_sel:[0,1,0] op_sel_hi:[1,1,0]
    v_pk_fma_f32 v[30:31], v[30:31], v[240:241], v[240:241] op_sel:[0,1,0] op_sel_hi:[1,1,0]
    v_pk_fma_f32 v[32:33], v[32:33], v[240:241], v[240:241] op_sel:[0,1,0] op_sel_hi:[1,1,0]
    v_pk_fma_f32 v[34:35], v[34:35], v[240:241], v[240:241] op_sel:[0,1,0] op_sel_hi:[1,1,0]
    s_waitcnt lgkmcnt(0)
    s_barrier
    ds_read_b128 v[168:171], v248 offset:0
    ds_read_b128 v[172:175], v248 offset:256
    ds_read_b128 v[176:179], v248 offset:512
    s_mov_b32 s36, 0x21800000
    s_mov_b32 s37, 0x5f800000
    ds_read_b64 v[36:37], v226 offset:0
    ds_read_b64 v[38:39], v227 offset:0
    ds_read_b64 v[40:41], v228 offset:0
    ds_read_b64 v[42:43], v226 offset:512
    ds_read_b64 v[44:45], v227 offset:512
    ds_read_b64 v[46:47], v228 offset:512
    ds_read_b64 v[48:49], v226 offset:1024
    ds_read_b64 v[50:51], v227 offset:1024
    ds_read_b64 v[52:53], v228 offset:1024
    ds_read_b64 v[54:55], v226 offset:1536
    ds_read_b64 v[56:57], v227 offset:1536
    ds_read_b64 v[58:59], v228 offset:1536
    s_waitcnt lgkmcnt(10)
    v_mfma_f32_16x16x32_bf16 v[108:111], a[232:235], v[36:39], v[108:111]
    ds_read_b64 v[60:61], v226 offset:2048
    ds_read_b64 v[62:63], v227 offset:2048
    s_waitcnt lgkmcnt(9)
    v_mfma_f32_16x16x32_bf16 v[112:115], a[232:235], v[42:45], v[112:115]
    ds_read_b64 v[64:65], v228 offset:2048
    ds_read_b64 v[66:67], v226 offset:2560
    s_waitcnt lgkmcnt(8)
    v_mfma_f32_16x16x32_bf16 v[116:119], a[232:235], v[48:51], v[116:119]
    ds_read_b64 v[68:69], v227 offset:2560
    ds_read_b64 v[70:71], v228 offset:2560
    v_add_f32_e64 v168, v168, v169
    s_waitcnt lgkmcnt(7)
    v_mfma_f32_16x16x32_bf16 v[120:123], a[232:235], v[54:57], v[120:123]
    ds_read_b64 v[72:73], v226 offset:3072
    ds_read_b64 v[74:75], v227 offset:3072
    v_add_f32 v170, v170, v171
    v_mfma_f32_16x16x16_bf16 v[108:111], a[232:233], v[40:41], v[108:111]
    ds_read_b64 v[76:77], v228 offset:3072
    ds_read_b64 v[78:79], v226 offset:3584
    v_add_f32_e64 v168, v168, v170
    s_waitcnt lgkmcnt(8)
    v_mfma_f32_16x16x32_bf16 v[124:127], a[232:235], v[60:63], v[124:127]
    ds_read_b64 v[80:81], v227 offset:3584
    ds_read_b64 v[82:83], v228 offset:3584
    v_add_f32 v172, v172, v173
    v_mfma_f32_16x16x16_bf16 v[112:115], a[232:233], v[46:47], v[112:115]
    ds_read_b64 v[84:85], v226 offset:4096
    ds_read_b64 v[86:87], v227 offset:4096
    v_add_f32_e64 v174, v174, v175
    s_waitcnt lgkmcnt(9)
    v_mfma_f32_16x16x32_bf16 v[128:131], a[232:235], v[66:69], v[128:131]
    ds_read_b64 v[88:89], v228 offset:4096
    v_add_f32 v172, v172, v174
    v_mfma_f32_16x16x16_bf16 v[116:119], a[232:233], v[52:53], v[116:119]
    v_add_f32 v176, v176, v177
    s_waitcnt lgkmcnt(7)
    v_mfma_f32_16x16x32_bf16 v[132:135], a[232:235], v[72:75], v[132:135]
    v_add_f32 v178, v178, v179
    v_mfma_f32_16x16x16_bf16 v[120:123], a[232:233], v[58:59], v[120:123]
    v_add_f32 v176, v176, v178
    s_waitcnt lgkmcnt(4)
    v_mfma_f32_16x16x32_bf16 v[136:139], a[232:235], v[78:81], v[136:139]
    v_cmp_le_f32 s[38:39], s36, v168
    v_mfma_f32_16x16x16_bf16 v[124:127], a[232:233], v[64:65], v[124:127]
    v_cmp_ge_f32 s[40:41], s37, v168
    s_waitcnt lgkmcnt(1)
    v_mfma_f32_16x16x32_bf16 v[140:143], a[232:235], v[84:87], v[140:143]
    v_rcp_f32 v180, v168
    v_mfma_f32_16x16x16_bf16 v[128:131], a[232:233], v[70:71], v[128:131]
    v_cmp_le_f32 s[42:43], s36, v172
    v_mfma_f32_16x16x16_bf16 v[132:135], a[232:233], v[76:77], v[132:135]
    v_cmp_ge_f32 s[44:45], s37, v172
    v_mfma_f32_16x16x16_bf16 v[136:139], a[232:233], v[82:83], v[136:139]
    v_rcp_f32 v182, v172
    s_waitcnt lgkmcnt(0)
    v_mfma_f32_16x16x16_bf16 v[140:143], a[232:233], v[88:89], v[140:143]
    v_cmp_le_f32 s[46:47], s36, v176
    v_cmp_ge_f32 vcc, s37, v176
    v_rcp_f32 v184, v176
    s_and_b64 s[38:39], s[38:39], s[40:41]
    s_and_b64 s[38:39], s[38:39], s[42:43]
    s_and_b64 s[38:39], s[38:39], s[44:45]
    s_and_b64 s[38:39], s[38:39], s[46:47]
    s_and_b64 s[38:39], s[38:39], vcc
    s_cmp_eq_u64 s[38:39], exec
    s_cselect_b32 s36, 1, s26
    s_cmp_eq_u32 s36, 0
    s_cbranch_scc1 K2_FALLBACK
    v_pk_mul_f32 v[108:109], v[108:109], v[180:181] op_sel_hi:[1,0]
    v_pk_mul_f32 v[110:111], v[110:111], v[180:181] op_sel_hi:[1,0]
    v_pk_mul_f32 v[112:113], v[112:113], v[182:183] op_sel_hi:[1,0]
    v_pk_mul_f32 v[114:115], v[114:115], v[182:183] op_sel_hi:[1,0]
    v_cvt_pk_bf16_f32 v108, v108, v109
    s_nop 0
    v_cvt_pk_bf16_f32 v109, v110, v111
    ds_write_b64 v252, v[108:109] offset:0
    v_pk_mul_f32 v[116:117], v[116:117], v[184:185] op_sel_hi:[1,0]
    v_pk_mul_f32 v[118:119], v[118:119], v[184:185] op_sel_hi:[1,0]
    v_cvt_pk_bf16_f32 v112, v112, v113
    v_cvt_pk_bf16_f32 v113, v114, v115
    ds_write_b64 v252, v[112:113] offset:1024
    v_pk_mul_f32 v[120:121], v[120:121], v[180:181] op_sel_hi:[1,0]
    v_pk_mul_f32 v[122:123], v[122:123], v[180:181] op_sel_hi:[1,0]
    v_cvt_pk_bf16_f32 v116, v116, v117
    v_cvt_pk_bf16_f32 v117, v118, v119
    ds_write_b64 v252, v[116:117] offset:2048
    v_pk_mul_f32 v[124:125], v[124:125], v[182:183] op_sel_hi:[1,0]
    v_pk_mul_f32 v[126:127], v[126:127], v[182:183] op_sel_hi:[1,0]
    v_cvt_pk_bf16_f32 v120, v120, v121
    v_cvt_pk_bf16_f32 v121, v122, v123
    ds_write_b64 v253, v[120:121] offset:0
    v_pk_mul_f32 v[128:129], v[128:129], v[184:185] op_sel_hi:[1,0]
    v_pk_mul_f32 v[130:131], v[130:131], v[184:185] op_sel_hi:[1,0]
    v_cvt_pk_bf16_f32 v124, v124, v125
    v_cvt_pk_bf16_f32 v125, v126, v127
    ds_write_b64 v253, v[124:125] offset:1024
    v_pk_mul_f32 v[132:133], v[132:133], v[180:181] op_sel_hi:[1,0]
    v_pk_mul_f32 v[134:135], v[134:135], v[180:181] op_sel_hi:[1,0]
    v_cvt_pk_bf16_f32 v128, v128, v129
    v_cvt_pk_bf16_f32 v129, v130, v131
    ds_write_b64 v253, v[128:129] offset:2048
    v_pk_mul_f32 v[136:137], v[136:137], v[182:183] op_sel_hi:[1,0]
    v_pk_mul_f32 v[138:139], v[138:139], v[182:183] op_sel_hi:[1,0]
    v_cvt_pk_bf16_f32 v132, v132, v133
    v_cvt_pk_bf16_f32 v133, v134, v135
    ds_write_b64 v254, v[132:133] offset:0
    v_pk_mul_f32 v[140:141], v[140:141], v[184:185] op_sel_hi:[1,0]
    v_pk_mul_f32 v[142:143], v[142:143], v[184:185] op_sel_hi:[1,0]
    v_cvt_pk_bf16_f32 v136, v136, v137
    v_cvt_pk_bf16_f32 v137, v138, v139
    ds_write_b64 v254, v[136:137] offset:1024
    v_cvt_pk_bf16_f32 v140, v140, v141
    v_cvt_pk_bf16_f32 v141, v142, v143
    ds_write_b64 v254, v[140:141] offset:2048
    s_mul_i32 s36, s13, 497664
    s_mul_i32 s37, s14, 18432
    s_add_u32 s36, s36, s37
    s_mul_i32 s37, s12, 96
    s_add_u32 s36, s36, s37
    s_add_u32 s37, s36, 6144
    s_add_u32 s38, s36, 12288
    v_mul_u32_u24 v186, 384, v243
    v_lshl_add_u32 v187, v244, 3, v186
    v_lshl_add_u32 v186, v244, 4, v186
    s_waitcnt lgkmcnt(0)
    s_barrier
    ds_read_b128 v[36:39], v255 offset:0
    ds_read_b128 v[40:43], v255 offset:3072
    ds_read_b128 v[44:47], v255 offset:6144
    ds_read_b128 v[48:51], v255 offset:9216
    ds_read_b128 v[52:55], v255 offset:12288
    ds_read_b128 v[56:59], v255 offset:15360
    s_waitcnt lgkmcnt(5)
    v_mfma_f32_16x16x32_bf16 v[0:3], a[160:163], v[36:39], v[0:3]
    ds_read_b128 v[60:63], v255 offset:1024
    v_mfma_f32_16x16x32_bf16 v[4:7], a[164:167], v[36:39], v[4:7]
    v_mfma_f32_16x16x32_bf16 v[8:11], a[168:171], v[36:39], v[8:11]
    s_waitcnt lgkmcnt(5)
    v_mfma_f32_16x16x32_bf16 v[0:3], a[172:175], v[40:43], v[0:3]
    ds_read_b128 v[64:67], v255 offset:4096
    v_mfma_f32_16x16x32_bf16 v[4:7], a[176:179], v[40:43], v[4:7]
    v_mfma_f32_16x16x32_bf16 v[8:11], a[180:183], v[40:43], v[8:11]
    s_waitcnt lgkmcnt(5)
    v_mfma_f32_16x16x32_bf16 v[0:3], a[184:187], v[44:47], v[0:3]
    ds_read_b128 v[68:71], v255 offset:7168
    v_mfma_f32_16x16x32_bf16 v[4:7], a[188:191], v[44:47], v[4:7]
    v_mfma_f32_16x16x32_bf16 v[8:11], a[192:195], v[44:47], v[8:11]
    s_waitcnt lgkmcnt(5)
    v_mfma_f32_16x16x32_bf16 v[0:3], a[196:199], v[48:51], v[0:3]
    ds_read_b128 v[72:75], v255 offset:10240
    v_mfma_f32_16x16x32_bf16 v[4:7], a[200:203], v[48:51], v[4:7]
    v_mfma_f32_16x16x32_bf16 v[8:11], a[204:207], v[48:51], v[8:11]
    s_waitcnt lgkmcnt(5)
    v_mfma_f32_16x16x32_bf16 v[0:3], a[208:211], v[52:55], v[0:3]
    ds_read_b128 v[76:79], v255 offset:13312
    v_mfma_f32_16x16x32_bf16 v[4:7], a[212:215], v[52:55], v[4:7]
    v_mfma_f32_16x16x32_bf16 v[8:11], a[216:219], v[52:55], v[8:11]
    s_waitcnt lgkmcnt(5)
    v_mfma_f32_16x16x32_bf16 v[0:3], a[220:223], v[56:59], v[0:3]
    ds_read_b128 v[80:83], v255 offset:16384
    v_mfma_f32_16x16x32_bf16 v[4:7], a[224:227], v[56:59], v[4:7]
    v_mfma_f32_16x16x32_bf16 v[8:11], a[228:231], v[56:59], v[8:11]
    s_waitcnt lgkmcnt(5)
    v_mfma_f32_16x16x32_bf16 v[12:15], a[160:163], v[60:63], v[12:15]
    ds_read_b128 v[84:87], v255 offset:2048
    v_mfma_f32_16x16x32_bf16 v[16:19], a[164:167], v[60:63], v[16:19]
    v_mfma_f32_16x16x32_bf16 v[20:23], a[168:171], v[60:63], v[20:23]
    s_waitcnt lgkmcnt(5)
    v_mfma_f32_16x16x32_bf16 v[12:15], a[172:175], v[64:67], v[12:15]
    ds_read_b128 v[88:91], v255 offset:5120
    v_cvt_pk_bf16_f32 v0, v0, v1
    v_mfma_f32_16x16x32_bf16 v[16:19], a[176:179], v[64:67], v[16:19]
    v_cvt_pk_bf16_f32 v1, v2, v3
    v_cvt_pk_bf16_f32 v2, v4, v5
    v_mfma_f32_16x16x32_bf16 v[20:23], a[180:183], v[64:67], v[20:23]
    v_cvt_pk_bf16_f32 v3, v6, v7
    v_cvt_pk_bf16_f32 v4, v8, v9
    s_waitcnt lgkmcnt(5)
    v_mfma_f32_16x16x32_bf16 v[12:15], a[184:187], v[68:71], v[12:15]
    ds_read_b128 v[92:95], v255 offset:8192
    v_cvt_pk_bf16_f32 v5, v10, v11
    v_mfma_f32_16x16x32_bf16 v[16:19], a[188:191], v[68:71], v[16:19]
    buffer_store_dwordx4 v[0:3], v186, s[8:11], s36 offen
    buffer_store_dwordx2 v[4:5], v187, s[8:11], s36 offen offset:64
    s_nop 0
    v_mfma_f32_16x16x32_bf16 v[20:23], a[192:195], v[68:71], v[20:23]
    s_waitcnt lgkmcnt(5)
    v_mfma_f32_16x16x32_bf16 v[12:15], a[196:199], v[72:75], v[12:15]
    ds_read_b128 v[96:99], v255 offset:11264
    v_mfma_f32_16x16x32_bf16 v[16:19], a[200:203], v[72:75], v[16:19]
    v_mfma_f32_16x16x32_bf16 v[20:23], a[204:207], v[72:75], v[20:23]
    s_waitcnt lgkmcnt(5)
    v_mfma_f32_16x16x32_bf16 v[12:15], a[208:211], v[76:79], v[12:15]
    ds_read_b128 v[100:103], v255 offset:14336
    v_mfma_f32_16x16x32_bf16 v[16:19], a[212:215], v[76:79], v[16:19]
    v_mfma_f32_16x16x32_bf16 v[20:23], a[216:219], v[76:79], v[20:23]
    s_waitcnt lgkmcnt(5)
    v_mfma_f32_16x16x32_bf16 v[12:15], a[220:223], v[80:83], v[12:15]
    ds_read_b128 v[104:107], v255 offset:17408
    v_mfma_f32_16x16x32_bf16 v[16:19], a[224:227], v[80:83], v[16:19]
    v_mfma_f32_16x16x32_bf16 v[20:23], a[228:231], v[80:83], v[20:23]
    s_waitcnt lgkmcnt(5)
    v_mfma_f32_16x16x32_bf16 v[24:27], a[160:163], v[84:87], v[24:27]
    v_mfma_f32_16x16x32_bf16 v[28:31], a[164:167], v[84:87], v[28:31]
    v_mfma_f32_16x16x32_bf16 v[32:35], a[168:171], v[84:87], v[32:35]
    s_waitcnt lgkmcnt(4)
    v_mfma_f32_16x16x32_bf16 v[24:27], a[172:175], v[88:91], v[24:27]
    v_cvt_pk_bf16_f32 v12, v12, v13
    v_cvt_pk_bf16_f32 v13, v14, v15
    v_mfma_f32_16x16x32_bf16 v[28:31], a[176:179], v[88:91], v[28:31]
    v_cvt_pk_bf16_f32 v14, v16, v17
    s_nop 0
    v_cvt_pk_bf16_f32 v15, v18, v19
    v_mfma_f32_16x16x32_bf16 v[32:35], a[180:183], v[88:91], v[32:35]
    v_cvt_pk_bf16_f32 v16, v20, v21
    v_cvt_pk_bf16_f32 v17, v22, v23
    s_waitcnt lgkmcnt(3)
    v_mfma_f32_16x16x32_bf16 v[24:27], a[184:187], v[92:95], v[24:27]
    buffer_store_dwordx4 v[12:15], v186, s[8:11], s37 offen
    buffer_store_dwordx2 v[16:17], v187, s[8:11], s37 offen offset:64
    s_nop 0
    v_mfma_f32_16x16x32_bf16 v[28:31], a[188:191], v[92:95], v[28:31]
    v_mfma_f32_16x16x32_bf16 v[32:35], a[192:195], v[92:95], v[32:35]
    s_waitcnt lgkmcnt(2)
    v_mfma_f32_16x16x32_bf16 v[24:27], a[196:199], v[96:99], v[24:27]
    v_mfma_f32_16x16x32_bf16 v[28:31], a[200:203], v[96:99], v[28:31]
    v_mfma_f32_16x16x32_bf16 v[32:35], a[204:207], v[96:99], v[32:35]
    s_waitcnt lgkmcnt(1)
    v_mfma_f32_16x16x32_bf16 v[24:27], a[208:211], v[100:103], v[24:27]
    v_mfma_f32_16x16x32_bf16 v[28:31], a[212:215], v[100:103], v[28:31]
    v_mfma_f32_16x16x32_bf16 v[32:35], a[216:219], v[100:103], v[32:35]
    s_waitcnt lgkmcnt(0)
    v_mfma_f32_16x16x32_bf16 v[24:27], a[220:223], v[104:107], v[24:27]
    v_mfma_f32_16x16x32_bf16 v[28:31], a[224:227], v[104:107], v[28:31]
    v_mfma_f32_16x16x32_bf16 v[32:35], a[228:231], v[104:107], v[32:35]
    s_nop 5
    v_cvt_pk_bf16_f32 v24, v24, v25
    v_cvt_pk_bf16_f32 v25, v26, v27
    v_cvt_pk_bf16_f32 v26, v28, v29
    v_cvt_pk_bf16_f32 v27, v30, v31
    v_cvt_pk_bf16_f32 v28, v32, v33
    v_cvt_pk_bf16_f32 v29, v34, v35
    buffer_store_dwordx4 v[24:27], v186, s[8:11], s38 offen
    buffer_store_dwordx2 v[28:29], v187, s[8:11], s38 offen offset:64
K2_EXIT:
    s_endpgm
K2_FALLBACK:
    s_waitcnt vmcnt(0) lgkmcnt(0)
    s_nop 7
    s_nop 7
    v_mfma_f32_16x16x32_bf16 v[148:151], a[112:115], a[0:3], 0
    v_mfma_f32_16x16x32_bf16 v[148:151], a[116:119], a[12:15], v[148:151]
    v_mfma_f32_16x16x32_bf16 v[148:151], a[120:123], a[24:27], v[148:151]
    v_mfma_f32_16x16x32_bf16 v[148:151], a[124:127], a[36:39], v[148:151]
    v_mfma_f32_16x16x32_bf16 v[148:151], a[128:131], a[48:51], v[148:151]
    v_mfma_f32_16x16x32_bf16 v[148:151], a[132:135], a[60:63], v[148:151]
    v_mfma_f32_16x16x32_bf16 v[152:155], a[112:115], a[4:7], 0
    v_mfma_f32_16x16x32_bf16 v[152:155], a[116:119], a[16:19], v[152:155]
    v_mfma_f32_16x16x32_bf16 v[152:155], a[120:123], a[28:31], v[152:155]
    v_mfma_f32_16x16x32_bf16 v[152:155], a[124:127], a[40:43], v[152:155]
    v_mfma_f32_16x16x32_bf16 v[152:155], a[128:131], a[52:55], v[152:155]
    v_mfma_f32_16x16x32_bf16 v[152:155], a[132:135], a[64:67], v[152:155]
    v_mfma_f32_16x16x32_bf16 v[156:159], a[112:115], a[8:11], 0
    v_mfma_f32_16x16x32_bf16 v[156:159], a[116:119], a[20:23], v[156:159]
    v_mfma_f32_16x16x32_bf16 v[156:159], a[120:123], a[32:35], v[156:159]
    v_mfma_f32_16x16x32_bf16 v[156:159], a[124:127], a[44:47], v[156:159]
    v_mfma_f32_16x16x32_bf16 v[156:159], a[128:131], a[56:59], v[156:159]
    v_mfma_f32_16x16x32_bf16 v[156:159], a[132:135], a[68:71], v[156:159]
    v_max3_f32 v144, v148, v149, v150
    v_max_f32 v144, v144, v151
    v_max3_f32 v145, v152, v153, v154
    v_max_f32 v145, v145, v155
    s_nop 3
    v_max3_f32 v146, v156, v157, v158
    v_max_f32_e64 v146, v146, v159
    s_mov_b32 s40, 0
    s_mul_i32 s41, s12, 122880
    s_mul_i32 s42, s13, 503808
    s_add_u32 s41, s41, s42
    s_nop 7
K2_FB_LOOP:
    s_add_u32 m0, s15, 0
    s_nop 0
    buffer_load_dwordx4 v210, s[4:7], s41 offen offset:0 lds
    buffer_load_dwordx4 v210, s[4:7], s41 offen offset:1024 lds
    buffer_load_dwordx4 v210, s[4:7], s41 offen offset:2048 lds
    buffer_load_dwordx4 v210, s[4:7], s41 offen offset:3072 lds
    s_add_u32 m0, s15, 4096
    s_nop 0
    buffer_load_dwordx4 v211, s[4:7], s41 offen offset:0 lds
    buffer_load_dwordx4 v211, s[4:7], s41 offen offset:1024 lds
    buffer_load_dwordx4 v211, s[4:7], s41 offen offset:2048 lds
    buffer_load_dwordx4 v211, s[4:7], s41 offen offset:3072 lds
    s_add_u32 m0, s15, 8192
    s_nop 0
    buffer_load_dwordx4 v212, s[4:7], s41 offen offset:0 lds
    buffer_load_dwordx4 v212, s[4:7], s41 offen offset:1024 lds
    buffer_load_dwordx4 v212, s[4:7], s41 offen offset:2048 lds
    buffer_load_dwordx4 v212, s[4:7], s41 offen offset:3072 lds
    s_waitcnt vmcnt(0)
    ds_read_b128 a[88:91], v204 offset:0
    ds_read_b128 a[92:95], v205 offset:0
    ds_read_b128 a[96:99], v204 offset:4096
    ds_read_b128 a[100:103], v205 offset:4096
    ds_read_b128 a[104:107], v204 offset:8192
    s_nop 0
    ds_read_b128 a[108:111], v205 offset:8192
    s_waitcnt lgkmcnt(5)
    v_mfma_f32_16x16x32_bf16 v[148:151], a[88:91], a[0:3], 0
    s_waitcnt lgkmcnt(4)
    v_mfma_f32_16x16x32_bf16 v[148:151], a[92:95], a[12:15], v[148:151]
    s_waitcnt lgkmcnt(3)
    v_mfma_f32_16x16x32_bf16 v[148:151], a[96:99], a[24:27], v[148:151]
    s_waitcnt lgkmcnt(2)
    v_mfma_f32_16x16x32_bf16 v[148:151], a[100:103], a[36:39], v[148:151]
    s_waitcnt lgkmcnt(1)
    s_nop 0
    v_mfma_f32_16x16x32_bf16 v[148:151], a[104:107], a[48:51], v[148:151]
    s_waitcnt lgkmcnt(0)
    v_mfma_f32_16x16x32_bf16 v[148:151], a[108:111], a[60:63], v[148:151]
    v_mfma_f32_16x16x32_bf16 v[152:155], a[88:91], a[4:7], 0
    v_mfma_f32_16x16x32_bf16 v[152:155], a[92:95], a[16:19], v[152:155]
    v_mfma_f32_16x16x32_bf16 v[152:155], a[96:99], a[28:31], v[152:155]
    v_mfma_f32_16x16x32_bf16 v[152:155], a[100:103], a[40:43], v[152:155]
    v_mfma_f32_16x16x32_bf16 v[152:155], a[104:107], a[52:55], v[152:155]
    s_nop 0
    v_mfma_f32_16x16x32_bf16 v[152:155], a[108:111], a[64:67], v[152:155]
    v_mfma_f32_16x16x32_bf16 v[156:159], a[88:91], a[8:11], 0
    v_mfma_f32_16x16x32_bf16 v[156:159], a[92:95], a[20:23], v[156:159]
    v_mfma_f32_16x16x32_bf16 v[156:159], a[96:99], a[32:35], v[156:159]
    v_mfma_f32_16x16x32_bf16 v[156:159], a[100:103], a[44:47], v[156:159]
    v_mfma_f32_16x16x32_bf16 v[156:159], a[104:107], a[56:59], v[156:159]
    v_mfma_f32_16x16x32_bf16 v[156:159], a[108:111], a[68:71], v[156:159]
    v_max3_f32 v144, v144, v148, v149
    v_max3_f32 v144, v144, v150, v151
    v_max3_f32 v145, v145, v152, v153
    v_max3_f32 v145, v145, v154, v155
    s_nop 3
    v_max3_f32 v146, v146, v156, v157
    v_max3_f32 v146, v146, v158, v159
    ds_read_b128 a[88:91], v204 offset:2048
    ds_read_b128 a[92:95], v205 offset:2048
    s_nop 0
    ds_read_b128 a[96:99], v204 offset:6144
    ds_read_b128 a[100:103], v205 offset:6144
    ds_read_b128 a[104:107], v204 offset:10240
    ds_read_b128 a[108:111], v205 offset:10240
    s_waitcnt lgkmcnt(5)
    v_mfma_f32_16x16x32_bf16 v[148:151], a[88:91], a[0:3], 0
    s_waitcnt lgkmcnt(4)
    v_mfma_f32_16x16x32_bf16 v[148:151], a[92:95], a[12:15], v[148:151]
    s_waitcnt lgkmcnt(3)
    s_nop 0
    v_mfma_f32_16x16x32_bf16 v[148:151], a[96:99], a[24:27], v[148:151]
    s_waitcnt lgkmcnt(2)
    v_mfma_f32_16x16x32_bf16 v[148:151], a[100:103], a[36:39], v[148:151]
    s_waitcnt lgkmcnt(1)
    v_mfma_f32_16x16x32_bf16 v[148:151], a[104:107], a[48:51], v[148:151]
    s_waitcnt lgkmcnt(0)
    v_mfma_f32_16x16x32_bf16 v[148:151], a[108:111], a[60:63], v[148:151]
    v_mfma_f32_16x16x32_bf16 v[152:155], a[88:91], a[4:7], 0
    v_mfma_f32_16x16x32_bf16 v[152:155], a[92:95], a[16:19], v[152:155]
    s_nop 0
    v_mfma_f32_16x16x32_bf16 v[152:155], a[96:99], a[28:31], v[152:155]
    v_mfma_f32_16x16x32_bf16 v[152:155], a[100:103], a[40:43], v[152:155]
    v_mfma_f32_16x16x32_bf16 v[152:155], a[104:107], a[52:55], v[152:155]
    v_mfma_f32_16x16x32_bf16 v[152:155], a[108:111], a[64:67], v[152:155]
    v_mfma_f32_16x16x32_bf16 v[156:159], a[88:91], a[8:11], 0
    v_mfma_f32_16x16x32_bf16 v[156:159], a[92:95], a[20:23], v[156:159]
    v_mfma_f32_16x16x32_bf16 v[156:159], a[96:99], a[32:35], v[156:159]
    v_mfma_f32_16x16x32_bf16 v[156:159], a[100:103], a[44:47], v[156:159]
    v_mfma_f32_16x16x32_bf16 v[156:159], a[104:107], a[56:59], v[156:159]
    v_mfma_f32_16x16x32_bf16 v[156:159], a[108:111], a[68:71], v[156:159]
    v_max3_f32 v144, v144, v148, v149
    v_max3_f32 v144, v144, v150, v151
    v_max3_f32 v145, v145, v152, v153
    v_max3_f32 v145, v145, v154, v155
    s_nop 3
    v_max3_f32 v146, v146, v156, v157
    s_nop 0
    v_max3_f32 v146, v146, v158, v159
    s_add_u32 s41, s41, 12288
    s_add_u32 s40, s40, 1
    s_nop 7
    s_cmp_lt_u32 s40, 10
    s_cbranch_scc1 K2_FB_LOOP
    v_mov_b32 v148, v144
    s_nop 1
    v_permlane16_swap_b32 v144, v148
    v_max_f32 v144, v144, v148
    v_mov_b32 v148, v144
    s_nop 1
    v_permlane32_swap_b32 v144, v148
    v_max_f32 v144, v144, v148
    v_mov_b32 v148, v145
    s_nop 1
    v_permlane16_swap_b32 v145, v148
    v_max_f32 v145, v145, v148
    v_mov_b32 v148, v145
    s_nop 1
    v_permlane32_swap_b32 v145, v148
    v_max_f32 v145, v145, v148
    v_mov_b32 v148, v146
    s_nop 1
    v_permlane16_swap_b32 v146, v148
    v_max_f32 v146, v146, v148
    v_mov_b32 v148, v146
    s_nop 1
    v_permlane32_swap_b32 v146, v148
    v_max_f32 v146, v146, v148
    v_lshlrev_b32 v148, 2, v243
    s_mul_i32 s36, s12, 192
    s_add_u32 s36, s36, 160768
    v_add_u32 v149, s36, v148
    v_add_u32 v148, 160768, v148
    ds_write_b32 v149, v144 offset:0
    ds_write_b32 v149, v145 offset:64
    ds_write_b32 v149, v146 offset:128
    s_waitcnt lgkmcnt(0)
    s_barrier
    ds_read_b32 v150, v148 offset:0
    ds_read_b32 v151, v148 offset:192
    ds_read_b32 v152, v148 offset:384
    ds_read_b32 v153, v148 offset:576
    ds_read_b32 v154, v148 offset:64
    ds_read_b32 v155, v148 offset:256
    ds_read_b32 v156, v148 offset:448
    ds_read_b32 v157, v148 offset:640
    ds_read_b32 v158, v148 offset:128
    ds_read_b32 v159, v148 offset:320
    ds_read_b32 v160, v148 offset:512
    ds_read_b32 v161, v148 offset:704
    s_waitcnt lgkmcnt(9)
    v_max3_f32 v150, v150, v151, v152
    s_waitcnt lgkmcnt(8)
    v_max_f32 v150, v150, v153
    v_sub_f32 v192, 0, v150
    v_sub_f32 v193, 0, v150
    v_sub_f32 v194, 0, v150
    v_sub_f32 v195, 0, v150
    s_waitcnt lgkmcnt(5)
    v_max3_f32 v154, v154, v155, v156
    s_waitcnt lgkmcnt(4)
    v_max_f32 v154, v154, v157
    v_sub_f32 v196, 0, v154
    v_sub_f32 v197, 0, v154
    v_sub_f32 v198, 0, v154
    v_sub_f32 v199, 0, v154
    s_waitcnt lgkmcnt(1)
    v_max3_f32 v158, v158, v159, v160
    s_waitcnt lgkmcnt(0)
    v_max_f32 v158, v158, v161
    v_sub_f32 v200, 0, v158
    v_sub_f32 v201, 0, v158
    v_sub_f32 v202, 0, v158
    v_sub_f32_e64 v203, 0, v158
    s_mov_b32 s26, 1
    s_barrier
    s_add_u32 m0, s15, 0
    s_nop 0
    buffer_load_dwordx4 v210, s[4:7], s16 offen offset:0 lds
    buffer_load_dwordx4 v210, s[4:7], s16 offen offset:1024 lds
    buffer_load_dwordx4 v210, s[4:7], s16 offen offset:2048 lds
    buffer_load_dwordx4 v210, s[4:7], s16 offen offset:3072 lds
    s_add_u32 m0, s15, 4096
    s_nop 0
    buffer_load_dwordx4 v211, s[4:7], s16 offen offset:0 lds
    buffer_load_dwordx4 v211, s[4:7], s16 offen offset:1024 lds
    buffer_load_dwordx4 v211, s[4:7], s16 offen offset:2048 lds
    buffer_load_dwordx4 v211, s[4:7], s16 offen offset:3072 lds
    s_add_u32 m0, s15, 8192
    s_nop 0
    buffer_load_dwordx4 v212, s[4:7], s16 offen offset:0 lds
    buffer_load_dwordx4 v212, s[4:7], s16 offen offset:1024 lds
    buffer_load_dwordx4 v212, s[4:7], s16 offen offset:2048 lds
    buffer_load_dwordx4 v212, s[4:7], s16 offen offset:3072 lds
    s_add_u32 m0, s15, 12288
    s_nop 0
    buffer_load_dwordx4 v210, s[4:7], s17 offen offset:0 lds
    buffer_load_dwordx4 v210, s[4:7], s17 offen offset:1024 lds
    buffer_load_dwordx4 v210, s[4:7], s17 offen offset:2048 lds
    s_nop 0
    buffer_load_dwordx4 v210, s[4:7], s17 offen offset:3072 lds
    s_add_u32 m0, s15, 16384
    s_nop 0
    buffer_load_dwordx4 v211, s[4:7], s17 offen offset:0 lds
    buffer_load_dwordx4 v211, s[4:7], s17 offen offset:1024 lds
    s_nop 7
    s_branch K2_RUN
K2_CODE_END:

.section .rodata,"a"
.p2align 6
.amdhsa_kernel k1_kernel
  .amdhsa_next_free_vgpr 512
  .amdhsa_next_free_sgpr 100
  .amdhsa_accum_offset 256
  .amdhsa_group_segment_fixed_size 0
  .amdhsa_kernarg_size 64
  .amdhsa_user_sgpr_count 2
  .amdhsa_user_sgpr_kernarg_segment_ptr 1
  .amdhsa_system_sgpr_workgroup_id_x 1
  .amdhsa_float_denorm_mode_32 3
.end_amdhsa_kernel
.text

.section .rodata,"a"
.p2align 6
.amdhsa_kernel k2_kernel
  .amdhsa_next_free_vgpr 512
  .amdhsa_next_free_sgpr 100
  .amdhsa_accum_offset 256
  .amdhsa_group_segment_fixed_size 0
  .amdhsa_kernarg_size 64
  .amdhsa_user_sgpr_count 2
  .amdhsa_user_sgpr_kernarg_segment_ptr 1
  .amdhsa_system_sgpr_workgroup_id_x 1
  .amdhsa_float_denorm_mode_32 3
.end_amdhsa_kernel
.text
```
